```python
import torch

def _softmax(x, axis=-1):
    return torch.softmax(x, dim=axis)
def _gelu(x):
    return torch.nn.functional.gelu(x, approximate="tanh")
def _silu(x):
    return torch.nn.functional.silu(x)
def _sigmoid(x):
    return torch.sigmoid(x)
def _layernorm(x, axis=-1, eps=1e-5):
    m = x.mean(dim=axis, keepdim=True)
    v = x.var(dim=axis, keepdim=True, unbiased=False)
    return (x - m) / torch.sqrt(v + eps)
def _scatter_add(tgt, idx, src, axis=0):
    return tgt.clone().index_add_(axis, idx, src)
def _segment_sum(src, seg, n):
    out = torch.zeros((n,) + src.shape[1:], dtype=src.dtype)
    return out.index_add_(0, seg, src)
def _pad(x, pw):
    flat = tuple(v for pair in reversed(pw) for v in pair)
    return torch.nn.functional.pad(x, flat)

kernel_name = 'gated_mix__sliding_block_cached__dense_activation_gelu__decode'

def setup_inputs():

    _w = (lambda a: (lambda t: t.to(torch.bfloat16) if t.is_floating_point() else t)(torch.as_tensor(a)))
    def _A_setup():
        B, Sq, D = 1, 1, 576
        Hq, Hkv, Sk, Dh = 32, 16, 32768, 128
        assert Hq % Hkv == 0, (Hq, Hkv)
        return {
            "x": _w((lambda *s: torch.randn(*s, dtype=torch.bfloat16) * 0.05)(B, Sq, D)),
            "k_cache": _w((lambda *s: torch.randn(*s, dtype=torch.bfloat16) * 3.2)(B, Hkv, Sk, Dh)),
            "v_cache": _w((lambda *s: torch.randn(*s, dtype=torch.bfloat16) * 0.2)(B, Hkv, Sk, Dh)),
            "wq": _w((lambda *s: torch.randn(*s, dtype=torch.bfloat16) * 3.2)(D, Hq * Dh) * (D ** -0.5)),
            "wo": _w((lambda *s: torch.randn(*s, dtype=torch.bfloat16) * 0.2)(Hq * Dh, D) * ((Hq * Dh) ** -0.5)),
        }
    _A_in = _A_setup()

    def _B_setup():
        B, S, D, F = 1, 1, 576, 4608
        return {
            "x": _w((lambda *s: torch.randn(*s, dtype=torch.bfloat16) * 0.05)(B, S, D)),
            "w1": _w((lambda *s: torch.randn(*s, dtype=torch.bfloat16) * 0.2)(D, F) * (D ** -0.5)),
            "b1": _w((lambda *s: torch.randn(*s, dtype=torch.bfloat16) * 0.2)(F) * 0.01),
            "w2": _w((lambda *s: torch.randn(*s, dtype=torch.bfloat16) * 0.2)(F, D) * (F ** -0.5)),
            "b2": _w((lambda *s: torch.randn(*s, dtype=torch.bfloat16) * 0.05)(D) * 0.01),
        }
    _B_in = _B_setup()

    return {
        "A_x": _A_in["x"],
        "A_k_cache": _A_in["k_cache"],
        "A_v_cache": _A_in["v_cache"],
        "A_wq": _A_in["wq"],
        "A_wo": _A_in["wo"],
        "B_x": _B_in["x"],
        "B_w1": _B_in["w1"],
        "B_b1": _B_in["b1"],
        "B_w2": _B_in["w2"],
        "B_b2": _B_in["b2"],
        "gate_w": _w((lambda *s: torch.randn(*s, dtype=torch.bfloat16) * 0.05)(576) * 16.0),
    }

def reference(A_x, A_k_cache, A_v_cache, A_wq, A_wo, B_x, B_w1, B_b1, B_w2, B_b2, gate_w):
    def _A_ref(x, k_cache, v_cache, wq, wo):
        B, Sq, D = x.shape
        Hq, Dh = 32, 128
        Hkv, Sk = k_cache.shape[1], k_cache.shape[2]
        W = min(4096, max(256, Sk // 4))
        rep = Hq // Hkv
        q = (lambda x, *d: x.permute(*d))((x @ wq).reshape(B, Sq, Hq, Dh), 0, 2, 1, 3)
        k = (lambda x, n, axis: torch.repeat_interleave(x, n, dim=axis))(k_cache[:, :, Sk - W:, :], rep, axis=1)
        v = (lambda x, n, axis: torch.repeat_interleave(x, n, dim=axis))(v_cache[:, :, Sk - W:, :], rep, axis=1)
        scores = torch.einsum("bhqd,bhkd->bhqk", q, k) * (Dh ** -0.5)
        p = _softmax(scores, axis=-1)
        o = torch.einsum("bhqk,bhkd->bhqd", p, v)
        return (lambda x, *d: x.permute(*d))(o, 0, 2, 1, 3).reshape(B, Sq, Hq * Dh) @ wo

    def _B_ref(x, w1, b1, w2, b2):
        h = torch.einsum("bsd,df->bsf", x, w1) + b1
        h = _gelu(h)
        return torch.einsum("bsf,fd->bsd", h, w2) + b2

    x = A_x
    g = _sigmoid((x * gate_w).sum(-1, keepdims=True))
    a = _A_ref(x, A_k_cache, A_v_cache, A_wq, A_wo)
    b = _B_ref(x, B_w1, B_b1, B_w2, B_b2)
    return g * a + (1 - g) * b
```

```asm
; @launch grid=(256,1,1) block=(704,1,1) lds=110592
.amdgcn_target "amdgcn-amd-amdhsa--gfx950"
.text
.globl gated_mix__sliding_block_cached__dense_activation_gelu__decode_kernel
.p2align 8
.type gated_mix__sliding_block_cached__dense_activation_gelu__decode_kernel,@function
gated_mix__sliding_block_cached__dense_activation_gelu__decode_kernel:
L_start:
    s_load_dwordx16 s[8:23], s[0:1], 0
    s_load_dwordx8 s[24:31], s[0:1], 64
    s_load_dwordx2 s[32:33], s[0:1], 104
    s_cmp_ge_u32 s2, 256
    s_cbranch_scc1 L_end
    v_lshrrev_b32 v1, 6, v0
    v_and_b32 v2, 63, v0
    v_readfirstlane_b32 s3, v1
    v_lshrrev_b32 v4, 4, v2
    v_bfe_u32 v9, v2, 3, 1
    v_lshl_add_u32 v5, v9, 2, v4
    v_and_b32 v6, 7, v2
    v_and_b32 v3, 15, v2
    v_lshlrev_b32 v8, 4, v2
    v_lshlrev_b32 v1, 2, v2
    v_mov_b32 v15, 0
    s_and_b32 s4, s2, 7
    s_lshl_b32 s35, s4, 1
    s_bfe_u32 s65, s2, 0x10003
    s_add_u32 s35, s35, s65
    s_lshr_b32 s36, s2, 4
    s_lshl_b32 s4, s4, 5
    s_lshr_b32 s5, s2, 3
    s_add_u32 s4, s4, s5
    s_cmp_eq_u32 s3, 0
    s_cbranch_scc1 L_loader
    s_cmp_lg_u32 s3, 1
    s_cbranch_scc1 L_kv
    s_getpc_b64 s[72:73]
L_pc:
    v_lshlrev_b32 v9, 7, v2
    global_load_dword v32, v9, s[72:73]
    v_add_u32 v9, 8192, v9
    v_min_u32 v9, L_codeend-L_pc-4, v9
    global_load_dword v33, v9, s[72:73]
    ds_write_b32 v1, v15 offset:1792
    ds_write_b32 v1, v15 offset:848
    s_branch L_pwave
L_loader:
    s_setprio 3
    s_lshr_b32 s72, s36, 2
    s_and_b32 s73, s36, 3
    s_lshl_b32 s74, s35, 2
    s_add_u32 s73, s73, s74
    s_mul_i32 s68, s72, 1179648
    s_lshl_b32 s74, s73, 7
    s_add_u32 s68, s68, s74
    s_mul_i32 s69, s72, 288
    v_mul_u32_u24 v13, 147456, v5
    v_lshl_add_u32 v13, v6, 4, v13
    v_mul_u32_u24 v14, 36, v5
    s_mov_b32 s42, 4718592
    s_mov_b32 s43, 0x20000
    s_movk_i32 s46, 1152
    s_mov_b32 s47, 0x20000
    v_lshlrev_b32 v9, 2, v4
    v_xor_b32 v9, v9, v3
    v_lshlrev_b32 v9, 4, v9
    v_lshl_add_u32 v60, v4, 8, v9
    v_xor_b32 v61, 16, v60
    v_xor_b32 v62, 32, v60
    v_xor_b32 v63, 48, v60
    s_lshl_b32 s38, s35, 23
    s_lshl_b32 s75, s36, 16
    s_add_u32 s38, s38, s75
    s_mul_i32 s75, s2, 2654435761
    s_lshr_b32 s75, s75, 28
    s_lshl_b32 s75, s75, 12
    s_add_u32 s38, s38, s75
    s_add_u32 s38, s38, 7340032
    s_mov_b32 s50, 134217728
    s_mov_b32 s51, 0x20000
    s_waitcnt lgkmcnt(0)
    s_mov_b64 s[40:41], s[14:15]
    s_mov_b64 s[44:45], s[8:9]
    s_mov_b64 s[48:49], s[10:11]
    buffer_load_dwordx4 v[36:39], v14, s[44:47], s69 offen offset:0
    buffer_load_dwordx4 v[40:43], v14, s[44:47], s69 offen offset:16
    buffer_load_dwordx4 v[44:47], v14, s[44:47], s69 offen offset:32
    buffer_load_dwordx4 v[72:75], v13, s[40:43], s68 offen nt
    s_add_u32 s68, s68, 0x2000
    buffer_load_dwordx4 v[76:79], v13, s[40:43], s68 offen nt
    s_add_u32 s68, s68, 0x2000
    buffer_load_dwordx4 v[80:83], v13, s[40:43], s68 offen nt
    s_add_u32 s68, s68, 0x2000
    buffer_load_dwordx4 v[84:87], v13, s[40:43], s68 offen nt
    s_add_u32 s68, s68, 0x2000
    buffer_load_dwordx4 v[88:91], v13, s[40:43], s68 offen nt
    s_add_u32 s68, s68, 0x2000
    buffer_load_dwordx4 v[92:95], v13, s[40:43], s68 offen nt
    s_add_u32 s68, s68, 0x2000
    buffer_load_dwordx4 v[96:99], v13, s[40:43], s68 offen nt
    s_add_u32 s68, s68, 0x2000
    buffer_load_dwordx4 v[100:103], v13, s[40:43], s68 offen nt
    s_add_u32 s68, s68, 0x2000
    buffer_load_dwordx4 v[104:107], v13, s[40:43], s68 offen nt
    s_add_u32 s68, s68, 0x2000
    buffer_load_dwordx4 v[108:111], v13, s[40:43], s68 offen nt
    s_add_u32 s68, s68, 0x2000
    buffer_load_dwordx4 v[112:115], v13, s[40:43], s68 offen nt
    s_add_u32 s68, s68, 0x2000
    buffer_load_dwordx4 v[116:119], v13, s[40:43], s68 offen nt
    s_add_u32 s68, s68, 0x2000
    buffer_load_dwordx4 v[120:123], v13, s[40:43], s68 offen nt
    s_add_u32 s68, s68, 0x2000
    buffer_load_dwordx4 v[124:127], v13, s[40:43], s68 offen nt
    s_add_u32 s68, s68, 0x2000
    buffer_load_dwordx4 v[128:131], v13, s[40:43], s68 offen nt
    s_add_u32 s68, s68, 0x2000
    buffer_load_dwordx4 v[132:135], v13, s[40:43], s68 offen nt
    s_add_u32 s68, s68, 0x2000
    buffer_load_dwordx4 v[136:139], v13, s[40:43], s68 offen nt
    s_add_u32 s68, s68, 0x2000
    buffer_load_dwordx4 v[140:143], v13, s[40:43], s68 offen nt
    s_xor_b32 s39, s38, 0
    s_mov_b32 m0, 45056
    s_nop 0
    buffer_load_dwordx4 v60, s[48:51], s39 offen offset:0 nt lds
    buffer_load_dwordx4 v61, s[48:51], s39 offen offset:1024 nt lds
    buffer_load_dwordx4 v62, s[48:51], s39 offen offset:2048 nt lds
    s_load_dword s34, s[32:33], 0
    s_mov_b64 s[56:57], s[32:33]
    s_mov_b32 s58, 536870912
    s_mov_b32 s59, 0x20000
    s_lshl_b32 s70, s35, 12
    s_lshl_b32 s74, s36, 8
    s_add_u32 s70, s70, s74
    s_add_u32 s70, s70, 65536
    v_lshl_add_u32 v14, v4, 3, v6
    v_lshlrev_b32 v14, 4, v14
    v_mov_b32 v24, 0
    v_mov_b32 v25, 0
    v_mov_b32 v26, 0
    v_mov_b32 v27, 0
    s_mov_b64 exec, 0x00ff00ff
    buffer_store_dwordx4 v[24:27], v14, s[56:59], s70 offen
    s_mov_b64 exec, -1
    v_and_b32 v9, 1, v2
    v_cmp_eq_u32 vcc, 1, v9
    v_mov_b32 v10, 0x0c0c0100
    v_mov_b32 v11, 0x01000c0c
    v_cndmask_b32 v10, v10, v11, vcc
    v_mov_b32 v11, 0x0c0c0302
    v_mov_b32 v12, 0x03020c0c
    v_cndmask_b32 v11, v11, v12, vcc
    v_mov_b32 v12, 0x0c0c0c0c
    v_lshrrev_b32 v9, 1, v6
    v_cmp_eq_u32 vcc, 0, v9
    s_mov_b32 s60, 0x07060500
    s_nop 0
    v_cndmask_b32 v16, v12, v10, vcc
    v_cndmask_b32 v20, v12, v11, vcc
    v_cmp_eq_u32 vcc, 1, v9
    s_mov_b32 s61, 0x07060501
    s_nop 0
    v_cndmask_b32 v17, v12, v10, vcc
    v_cndmask_b32 v21, v12, v11, vcc
    v_cmp_eq_u32 vcc, 2, v9
    s_mov_b32 s62, 0x07060502
    s_nop 0
    v_cndmask_b32 v18, v12, v10, vcc
    v_cndmask_b32 v22, v12, v11, vcc
    v_cmp_eq_u32 vcc, 3, v9
    s_mov_b32 s63, 0x07060503
    s_nop 0
    v_cndmask_b32 v19, v12, v10, vcc
    v_cndmask_b32 v23, v12, v11, vcc
    s_mov_b32 s64, 0x0c0c0400
    s_getreg_b32 s6, hwreg(HW_REG_XCC_ID)
    s_and_b32 s6, s6, 15
    s_lshl_b32 s6, s6, 8
    s_movk_i32 s7, 0xf00
    v_mov_b32 v0, s6
    s_mov_b32 s78, 0
    s_add_u32 s74, s5, 1
    s_lshr_b32 s74, s74, 3
    s_sub_u32 s75, s5, s74
    s_and_b32 s74, s5, 7
    s_cmp_eq_u32 s74, 6
    s_cselect_b32 s75, 27, s75
    s_mov_b32 s72, 0
    s_cmp_ge_u32 s75, 9
    s_addc_u32 s72, s72, 0
    s_cmp_ge_u32 s75, 18
    s_addc_u32 s72, s72, 0
    s_and_b32 s73, s2, 7
    s_sub_u32 s73, s73, s72
    s_mul_i32 s73, s73, 9
    s_add_u32 s73, s73, s75
    s_mul_i32 s66, s72, 1769472
    s_lshl_b32 s74, s73, 7
    s_add_u32 s66, s66, s74
    s_mul_i32 s67, s72, 384
    s_mul_i32 s71, s72, 18432
    s_lshl_b32 s74, s73, 8
    s_add_u32 s71, s71, s74
    s_add_u32 s71, s71, 131072
    s_cmp_ge_u32 s75, 27
    s_cselect_b32 s74, 0x70000000, 0
    v_mul_u32_u24 v65, 221184, v5
    v_lshl_add_u32 v65, v6, 4, v65
    v_add_u32 v65, s74, v65
    v_mul_u32_u24 v66, 48, v5
    v_add_u32 v67, s74, v14
    s_mov_b64 s[52:53], s[20:21]
    s_mov_b32 s54, 5308416
    s_mov_b32 s55, 0x20000
    s_mov_b64 exec, 0x00ff00ff
    buffer_store_dwordx4 v[24:27], v67, s[56:59], s71 offen
    s_mov_b64 exec, -1
    s_mul_i32 s76, s35, 18432
    s_mul_i32 s77, s36, 1152
    s_add_u32 s77, s77, s76
    s_add_u32 s77, s77, 524288
    buffer_store_dwordx4 v[24:27], v8, s[56:59], s77 offen
    v_lshlrev_b32 v69, 7, v5
    s_waitcnt vmcnt(23)
    v_perm_b32 v52, v36, v36, v16
    v_perm_b32 v53, v36, v36, v17
    v_perm_b32 v54, v36, v36, v18
    v_perm_b32 v55, v36, v36, v19
    s_nop 1
    v_mfma_f32_16x16x32_bf16 v[28:31], v[52:55], v[72:75], 0
    buffer_load_dwordx4 v63, s[48:51], s39 offen offset:3072 nt lds
    v_perm_b32 v56, v36, v36, v20
    v_perm_b32 v57, v36, v36, v21
    v_perm_b32 v58, v36, v36, v22
    v_perm_b32 v59, v36, v36, v23
    s_nop 0
    s_xor_b32 s39, s38, 4096
    s_mov_b32 m0, 49152
    s_waitcnt vmcnt(23)
    v_mfma_f32_16x16x32_bf16 v[28:31], v[56:59], v[76:79], v[28:31]
    buffer_load_dwordx4 v60, s[48:51], s39 offen offset:0 nt lds
    v_perm_b32 v52, v37, v37, v16
    v_perm_b32 v53, v37, v37, v17
    v_perm_b32 v54, v37, v37, v18
    v_perm_b32 v55, v37, v37, v19
    s_nop 0
    s_waitcnt vmcnt(23)
    v_mfma_f32_16x16x32_bf16 v[28:31], v[52:55], v[80:83], v[28:31]
    buffer_load_dwordx4 v61, s[48:51], s39 offen offset:1024 nt lds
    v_perm_b32 v56, v37, v37, v20
    v_perm_b32 v57, v37, v37, v21
    v_perm_b32 v58, v37, v37, v22
    v_perm_b32 v59, v37, v37, v23
    s_nop 0
    s_waitcnt vmcnt(23)
    v_mfma_f32_16x16x32_bf16 v[28:31], v[56:59], v[84:87], v[28:31]
    buffer_load_dwordx4 v62, s[48:51], s39 offen offset:2048 nt lds
    v_perm_b32 v52, v38, v38, v16
    v_perm_b32 v53, v38, v38, v17
    v_perm_b32 v54, v38, v38, v18
    v_perm_b32 v55, v38, v38, v19
    s_nop 0
    s_waitcnt vmcnt(23)
    v_mfma_f32_16x16x32_bf16 v[28:31], v[52:55], v[88:91], v[28:31]
    buffer_load_dwordx4 v63, s[48:51], s39 offen offset:3072 nt lds
    v_perm_b32 v56, v38, v38, v20
    v_perm_b32 v57, v38, v38, v21
    v_perm_b32 v58, v38, v38, v22
    v_perm_b32 v59, v38, v38, v23
    s_nop 0
    s_xor_b32 s39, s38, 8192
    s_mov_b32 m0, 53248
    s_waitcnt vmcnt(23)
    v_mfma_f32_16x16x32_bf16 v[28:31], v[56:59], v[92:95], v[28:31]
    buffer_load_dwordx4 v60, s[48:51], s39 offen offset:0 nt lds
    v_perm_b32 v52, v39, v39, v16
    v_perm_b32 v53, v39, v39, v17
    v_perm_b32 v54, v39, v39, v18
    v_perm_b32 v55, v39, v39, v19
    s_nop 0
    s_waitcnt vmcnt(23)
    v_mfma_f32_16x16x32_bf16 v[28:31], v[52:55], v[96:99], v[28:31]
    buffer_load_dwordx4 v61, s[48:51], s39 offen offset:1024 nt lds
    v_perm_b32 v56, v39, v39, v20
    v_perm_b32 v57, v39, v39, v21
    v_perm_b32 v58, v39, v39, v22
    v_perm_b32 v59, v39, v39, v23
    s_nop 0
    s_waitcnt vmcnt(23)
    v_mfma_f32_16x16x32_bf16 v[28:31], v[56:59], v[100:103], v[28:31]
    buffer_load_dwordx4 v62, s[48:51], s39 offen offset:2048 nt lds
    v_perm_b32 v52, v40, v40, v16
    v_perm_b32 v53, v40, v40, v17
    v_perm_b32 v54, v40, v40, v18
    v_perm_b32 v55, v40, v40, v19
    s_nop 0
    s_waitcnt vmcnt(23)
    v_mfma_f32_16x16x32_bf16 v[28:31], v[52:55], v[104:107], v[28:31]
    buffer_load_dwordx4 v63, s[48:51], s39 offen offset:3072 nt lds
    v_perm_b32 v56, v40, v40, v20
    v_perm_b32 v57, v40, v40, v21
    v_perm_b32 v58, v40, v40, v22
    v_perm_b32 v59, v40, v40, v23
    s_nop 0
    s_xor_b32 s39, s38, 12288
    s_mov_b32 m0, 57344
    s_waitcnt vmcnt(23)
    v_mfma_f32_16x16x32_bf16 v[28:31], v[56:59], v[108:111], v[28:31]
    buffer_load_dwordx4 v60, s[48:51], s39 offen offset:0 nt lds
    v_perm_b32 v52, v41, v41, v16
    v_perm_b32 v53, v41, v41, v17
    v_perm_b32 v54, v41, v41, v18
    v_perm_b32 v55, v41, v41, v19
    s_nop 0
    s_waitcnt vmcnt(23)
    v_mfma_f32_16x16x32_bf16 v[28:31], v[52:55], v[112:115], v[28:31]
    buffer_load_dwordx4 v61, s[48:51], s39 offen offset:1024 nt lds
    v_perm_b32 v56, v41, v41, v20
    v_perm_b32 v57, v41, v41, v21
    v_perm_b32 v58, v41, v41, v22
    v_perm_b32 v59, v41, v41, v23
    s_nop 0
    s_waitcnt vmcnt(23)
    v_mfma_f32_16x16x32_bf16 v[28:31], v[56:59], v[116:119], v[28:31]
    buffer_load_dwordx4 v62, s[48:51], s39 offen offset:2048 nt lds
    v_perm_b32 v52, v42, v42, v16
    v_perm_b32 v53, v42, v42, v17
    v_perm_b32 v54, v42, v42, v18
    v_perm_b32 v55, v42, v42, v19
    s_nop 0
    s_waitcnt vmcnt(23)
    v_mfma_f32_16x16x32_bf16 v[28:31], v[52:55], v[120:123], v[28:31]
    buffer_load_dwordx4 v63, s[48:51], s39 offen offset:3072 nt lds
    v_perm_b32 v56, v42, v42, v20
    v_perm_b32 v57, v42, v42, v21
    v_perm_b32 v58, v42, v42, v22
    v_perm_b32 v59, v42, v42, v23
    s_nop 0
    s_xor_b32 s39, s38, 16384
    s_mov_b32 m0, 61440
    s_waitcnt vmcnt(23)
    v_mfma_f32_16x16x32_bf16 v[28:31], v[56:59], v[124:127], v[28:31]
    buffer_load_dwordx4 v60, s[48:51], s39 offen offset:0 nt lds
    v_perm_b32 v52, v43, v43, v16
    v_perm_b32 v53, v43, v43, v17
    v_perm_b32 v54, v43, v43, v18
    v_perm_b32 v55, v43, v43, v19
    s_nop 0
    s_waitcnt vmcnt(23)
    v_mfma_f32_16x16x32_bf16 v[28:31], v[52:55], v[128:131], v[28:31]
    buffer_load_dwordx4 v61, s[48:51], s39 offen offset:1024 nt lds
    v_perm_b32 v56, v43, v43, v20
    v_perm_b32 v57, v43, v43, v21
    v_perm_b32 v58, v43, v43, v22
    v_perm_b32 v59, v43, v43, v23
    s_nop 0
    s_waitcnt vmcnt(23)
    v_mfma_f32_16x16x32_bf16 v[28:31], v[56:59], v[132:135], v[28:31]
    buffer_load_dwordx4 v62, s[48:51], s39 offen offset:2048 nt lds
    v_perm_b32 v52, v44, v44, v16
    v_perm_b32 v53, v44, v44, v17
    v_perm_b32 v54, v44, v44, v18
    v_perm_b32 v55, v44, v44, v19
    s_nop 0
    s_waitcnt vmcnt(23)
    v_mfma_f32_16x16x32_bf16 v[28:31], v[52:55], v[136:139], v[28:31]
    buffer_load_dwordx4 v63, s[48:51], s39 offen offset:3072 nt lds
    v_perm_b32 v56, v44, v44, v20
    v_perm_b32 v57, v44, v44, v21
    v_perm_b32 v58, v44, v44, v22
    v_perm_b32 v59, v44, v44, v23
    s_nop 0
    s_xor_b32 s39, s38, 20480
    s_mov_b32 m0, 65536
    s_waitcnt vmcnt(23)
    v_mfma_f32_16x16x32_bf16 v[28:31], v[56:59], v[140:143], v[28:31]
    s_waitcnt lgkmcnt(0)
    s_add_u32 s34, s34, 0x01010101
    s_cmp_eq_u32 s34, 0
    s_cselect_b32 s34, 0x01010101, s34
    v_mov_b32 v7, s34
    s_nop 2
    v_permlane32_swap_b32 v28, v52
    v_permlane32_swap_b32 v29, v53
    v_permlane32_swap_b32 v30, v54
    v_permlane32_swap_b32 v31, v55
    v_add_f32_dpp v28, v52, v28 row_ror:8 row_mask:0xf bank_mask:0xf
    v_add_f32_dpp v29, v53, v29 row_ror:8 row_mask:0xf bank_mask:0xf
    v_add_f32_dpp v30, v54, v30 row_ror:8 row_mask:0xf bank_mask:0xf
    v_add_f32_dpp v31, v55, v31 row_ror:8 row_mask:0xf bank_mask:0xf
    v_perm_b32 v28, v28, v7, s60
    v_perm_b32 v29, v29, v7, s61
    v_perm_b32 v30, v30, v7, s62
    v_perm_b32 v31, v31, v7, s63
    v_bfi_b32 v31, s7, v0, v31
    s_mov_b64 exec, 0x00ff00ff
    buffer_store_dwordx4 v[28:31], v14, s[56:59], s70 offen
    s_mov_b64 exec, -1
    s_barrier
    buffer_load_dwordx4 v60, s[48:51], s39 offen offset:0 nt lds
    s_waitcnt vmcnt(23)
    buffer_load_dwordx4 v61, s[48:51], s39 offen offset:1024 nt lds
    s_waitcnt vmcnt(23)
    buffer_load_dwordx4 v62, s[48:51], s39 offen offset:2048 nt lds
    s_waitcnt vmcnt(23)
    buffer_load_dwordx4 v63, s[48:51], s39 offen offset:3072 nt lds
    s_xor_b32 s39, s38, 24576
    s_mov_b32 m0, 69632
    s_waitcnt vmcnt(23)
    buffer_load_dwordx4 v60, s[48:51], s39 offen offset:0 nt lds
    s_waitcnt vmcnt(23)
    buffer_load_dwordx4 v61, s[48:51], s39 offen offset:1024 nt lds
    s_waitcnt vmcnt(23)
    buffer_load_dwordx4 v62, s[48:51], s39 offen offset:2048 nt lds
    s_waitcnt vmcnt(23)
    buffer_load_dwordx4 v63, s[48:51], s39 offen offset:3072 nt lds
    s_xor_b32 s39, s38, 28672
    s_mov_b32 m0, 73728
    s_waitcnt vmcnt(23)
    buffer_load_dwordx4 v60, s[48:51], s39 offen offset:0 nt lds
    s_waitcnt vmcnt(23)
    buffer_load_dwordx4 v61, s[48:51], s39 offen offset:1024 nt lds
    s_waitcnt vmcnt(23)
    buffer_load_dwordx4 v62, s[48:51], s39 offen offset:2048 nt lds
    s_waitcnt vmcnt(23)
    buffer_load_dwordx4 v63, s[48:51], s39 offen offset:3072 nt lds
    s_xor_b32 s39, s38, 32768
    s_mov_b32 m0, 77824
    s_waitcnt vmcnt(23)
    buffer_load_dwordx4 v60, s[48:51], s39 offen offset:0 nt lds
    s_waitcnt vmcnt(23)
    buffer_load_dwordx4 v61, s[48:51], s39 offen offset:1024 nt lds
    s_waitcnt vmcnt(23)
    buffer_load_dwordx4 v62, s[48:51], s39 offen offset:2048 nt lds
    s_waitcnt vmcnt(23)
    buffer_load_dwordx4 v63, s[48:51], s39 offen offset:3072 nt lds
    s_xor_b32 s39, s38, 36864
    s_mov_b32 m0, 81920
    s_waitcnt vmcnt(23)
    buffer_load_dwordx4 v60, s[48:51], s39 offen offset:0 nt lds
    s_waitcnt vmcnt(23)
    buffer_load_dwordx4 v61, s[48:51], s39 offen offset:1024 nt lds
    s_waitcnt vmcnt(23)
    buffer_load_dwordx4 v62, s[48:51], s39 offen offset:2048 nt lds
    s_waitcnt vmcnt(23)
    buffer_load_dwordx4 v63, s[48:51], s39 offen offset:3072 nt lds
    s_xor_b32 s39, s38, 40960
    s_mov_b32 m0, 86016
    s_waitcnt vmcnt(23)
    buffer_load_dwordx4 v60, s[48:51], s39 offen offset:0 nt lds
    s_waitcnt vmcnt(23)
    buffer_load_dwordx4 v61, s[48:51], s39 offen offset:1024 nt lds
    s_waitcnt vmcnt(23)
    buffer_load_dwordx4 v62, s[48:51], s39 offen offset:2048 nt lds
    s_waitcnt vmcnt(23)
    buffer_load_dwordx4 v63, s[48:51], s39 offen offset:3072 nt lds
    s_xor_b32 s39, s38, 45056
    s_mov_b32 m0, 90112
    s_waitcnt vmcnt(23)
    buffer_load_dwordx4 v60, s[48:51], s39 offen offset:0 nt lds
    s_waitcnt vmcnt(23)
    buffer_load_dwordx4 v61, s[48:51], s39 offen offset:1024 nt lds
    s_waitcnt vmcnt(23)
    buffer_load_dwordx4 v62, s[48:51], s39 offen offset:2048 nt lds
    s_waitcnt vmcnt(23)
    buffer_load_dwordx4 v63, s[48:51], s39 offen offset:3072 nt lds
    s_xor_b32 s39, s38, 49152
    s_mov_b32 m0, 94208
    s_waitcnt vmcnt(23)
    buffer_load_dwordx4 v60, s[48:51], s39 offen offset:0 nt lds
    s_waitcnt vmcnt(23)
    buffer_load_dwordx4 v61, s[48:51], s39 offen offset:1024 nt lds
    s_waitcnt vmcnt(23)
    buffer_load_dwordx4 v62, s[48:51], s39 offen offset:2048 nt lds
    s_waitcnt vmcnt(23)
    buffer_load_dwordx4 v63, s[48:51], s39 offen offset:3072 nt lds
    s_xor_b32 s39, s38, 53248
    s_mov_b32 m0, 98304
    s_waitcnt vmcnt(23)
    buffer_load_dwordx4 v60, s[48:51], s39 offen offset:0 nt lds
    s_waitcnt vmcnt(23)
    buffer_load_dwordx4 v61, s[48:51], s39 offen offset:1024 nt lds
    s_waitcnt vmcnt(23)
    buffer_load_dwordx4 v62, s[48:51], s39 offen offset:2048 nt lds
    s_waitcnt vmcnt(23)
    buffer_load_dwordx4 v63, s[48:51], s39 offen offset:3072 nt lds
    s_xor_b32 s39, s38, 57344
    s_mov_b32 m0, 102400
    s_waitcnt vmcnt(23)
    buffer_load_dwordx4 v60, s[48:51], s39 offen offset:0 nt lds
    s_waitcnt vmcnt(23)
    buffer_load_dwordx4 v61, s[48:51], s39 offen offset:1024 nt lds
    s_waitcnt vmcnt(23)
    buffer_load_dwordx4 v62, s[48:51], s39 offen offset:2048 nt lds
    s_waitcnt vmcnt(23)
    buffer_load_dwordx4 v63, s[48:51], s39 offen offset:3072 nt lds
    v_mov_b32 v64, 57
    ds_write_b32 v1, v64 offset:1792
    s_xor_b32 s39, s38, 61440
    s_mov_b32 m0, 106496
    s_waitcnt vmcnt(23)
    buffer_load_dwordx4 v60, s[48:51], s39 offen offset:0 nt lds
    s_waitcnt vmcnt(23)
    buffer_load_dwordx4 v61, s[48:51], s39 offen offset:1024 nt lds
    s_waitcnt vmcnt(23)
    buffer_load_dwordx4 v62, s[48:51], s39 offen offset:2048 nt lds
    s_waitcnt vmcnt(23)
    buffer_load_dwordx4 v63, s[48:51], s39 offen offset:3072 nt lds
    v_mov_b32 v64, 61
    ds_write_b32 v1, v64 offset:1792
    s_waitcnt vmcnt(23)
    buffer_load_dwordx4 v[36:39], v66, s[44:47], s67 offen offset:0
    s_waitcnt vmcnt(23)
    buffer_load_dwordx4 v[40:43], v66, s[44:47], s67 offen offset:16
    s_waitcnt vmcnt(23)
    buffer_load_dwordx4 v[44:47], v66, s[44:47], s67 offen offset:32
    s_waitcnt vmcnt(23)
    buffer_load_dwordx4 v[144:147], v65, s[52:55], s66 offen nt
    s_add_u32 s66, s66, 0x2400
    v_mov_b32 v64, 65
    ds_write_b32 v1, v64 offset:1792
    s_waitcnt vmcnt(23)
    buffer_load_dwordx4 v[148:151], v65, s[52:55], s66 offen nt
    s_add_u32 s66, s66, 0x2400
    s_waitcnt vmcnt(23)
    buffer_load_dwordx4 v[152:155], v65, s[52:55], s66 offen nt
    s_add_u32 s66, s66, 0x2400
    s_waitcnt vmcnt(23)
    buffer_load_dwordx4 v[156:159], v65, s[52:55], s66 offen nt
    s_add_u32 s66, s66, 0x2400
    s_waitcnt vmcnt(23)
    buffer_load_dwordx4 v[160:163], v65, s[52:55], s66 offen nt
    s_add_u32 s66, s66, 0x2400
    v_mov_b32 v64, 69
    ds_write_b32 v1, v64 offset:1792
    s_waitcnt vmcnt(23)
    buffer_load_dwordx4 v[164:167], v65, s[52:55], s66 offen nt
    s_add_u32 s66, s66, 0x2400
    s_waitcnt vmcnt(23)
    buffer_load_dwordx4 v[72:75], v65, s[52:55], s66 offen nt
    s_add_u32 s66, s66, 0x2400
    s_waitcnt vmcnt(23)
    buffer_load_dwordx4 v[76:79], v65, s[52:55], s66 offen nt
    s_add_u32 s66, s66, 0x2400
    s_waitcnt vmcnt(23)
    buffer_load_dwordx4 v[80:83], v65, s[52:55], s66 offen nt
    s_add_u32 s66, s66, 0x2400
    v_mov_b32 v64, 73
    ds_write_b32 v1, v64 offset:1792
    s_waitcnt vmcnt(23)
    buffer_load_dwordx4 v[84:87], v65, s[52:55], s66 offen nt
    s_add_u32 s66, s66, 0x2400
    s_waitcnt vmcnt(23)
    buffer_load_dwordx4 v[88:91], v65, s[52:55], s66 offen nt
    s_add_u32 s66, s66, 0x2400
    s_waitcnt vmcnt(23)
    buffer_load_dwordx4 v[92:95], v65, s[52:55], s66 offen nt
    s_add_u32 s66, s66, 0x2400
    s_waitcnt vmcnt(23)
    buffer_load_dwordx4 v[96:99], v65, s[52:55], s66 offen nt
    s_add_u32 s66, s66, 0x2400
    v_mov_b32 v64, 77
    ds_write_b32 v1, v64 offset:1792
    s_waitcnt vmcnt(23)
    buffer_load_dwordx4 v[100:103], v65, s[52:55], s66 offen nt
    s_add_u32 s66, s66, 0x2400
    s_waitcnt vmcnt(23)
    buffer_load_dwordx4 v[104:107], v65, s[52:55], s66 offen nt
    s_add_u32 s66, s66, 0x2400
    s_waitcnt vmcnt(23)
    buffer_load_dwordx4 v[108:111], v65, s[52:55], s66 offen nt
    s_add_u32 s66, s66, 0x2400
    s_waitcnt vmcnt(23)
    buffer_load_dwordx4 v[112:115], v65, s[52:55], s66 offen nt
    s_add_u32 s66, s66, 0x2400
    v_mov_b32 v64, 81
    ds_write_b32 v1, v64 offset:1792
    s_waitcnt vmcnt(23)
    buffer_load_dwordx4 v[116:119], v65, s[52:55], s66 offen nt
    s_add_u32 s66, s66, 0x2400
    s_waitcnt vmcnt(23)
    buffer_load_dwordx4 v[120:123], v65, s[52:55], s66 offen nt
    s_add_u32 s66, s66, 0x2400
    s_waitcnt vmcnt(23)
    buffer_load_dwordx4 v[124:127], v65, s[52:55], s66 offen nt
    s_add_u32 s66, s66, 0x2400
    s_waitcnt vmcnt(23)
    buffer_load_dwordx4 v[128:131], v65, s[52:55], s66 offen nt
    s_add_u32 s66, s66, 0x2400
    v_mov_b32 v64, 85
    ds_write_b32 v1, v64 offset:1792
    s_waitcnt vmcnt(23)
    buffer_load_dwordx4 v[132:135], v65, s[52:55], s66 offen nt
    s_add_u32 s66, s66, 0x2400
    s_waitcnt vmcnt(23)
    buffer_load_dwordx4 v[136:139], v65, s[52:55], s66 offen nt
    s_add_u32 s66, s66, 0x2400
    s_waitcnt vmcnt(23)
    buffer_load_dwordx4 v[140:143], v65, s[52:55], s66 offen nt
    s_mov_b64 s[48:49], s[12:13]
    s_xor_b32 s39, s38, 0
    s_waitcnt vmcnt(23)
    v_perm_b32 v52, v36, v36, v16
    v_perm_b32 v53, v36, v36, v17
    v_perm_b32 v54, v36, v36, v18
    v_perm_b32 v55, v36, v36, v19
    s_nop 1
    v_mfma_f32_16x16x32_bf16 v[32:35], v[52:55], v[144:147], 0
    buffer_load_dwordx4 v[144:147], v8, s[48:51], s39 offen offset:0 nt
    v_perm_b32 v56, v36, v36, v20
    v_perm_b32 v57, v36, v36, v21
    v_perm_b32 v58, v36, v36, v22
    v_perm_b32 v59, v36, v36, v23
    s_nop 0
    s_waitcnt vmcnt(23)
    v_mfma_f32_16x16x32_bf16 v[32:35], v[56:59], v[148:151], v[32:35]
    buffer_load_dwordx4 v[148:151], v8, s[48:51], s39 offen offset:1024 nt
    v_perm_b32 v52, v37, v37, v16
    v_perm_b32 v53, v37, v37, v17
    v_perm_b32 v54, v37, v37, v18
    v_perm_b32 v55, v37, v37, v19
    s_nop 0
    s_waitcnt vmcnt(23)
    v_mfma_f32_16x16x32_bf16 v[32:35], v[52:55], v[152:155], v[32:35]
    buffer_load_dwordx4 v[152:155], v8, s[48:51], s39 offen offset:2048 nt
    v_perm_b32 v56, v37, v37, v20
    v_perm_b32 v57, v37, v37, v21
    v_perm_b32 v58, v37, v37, v22
    v_perm_b32 v59, v37, v37, v23
    s_nop 0
    s_waitcnt vmcnt(23)
    v_mfma_f32_16x16x32_bf16 v[32:35], v[56:59], v[156:159], v[32:35]
    buffer_load_dwordx4 v[156:159], v8, s[48:51], s39 offen offset:3072 nt
    v_perm_b32 v52, v38, v38, v16
    v_perm_b32 v53, v38, v38, v17
    v_perm_b32 v54, v38, v38, v18
    v_perm_b32 v55, v38, v38, v19
    s_nop 0
    s_xor_b32 s39, s38, 4096
    s_waitcnt vmcnt(23)
    v_mfma_f32_16x16x32_bf16 v[32:35], v[52:55], v[160:163], v[32:35]
    buffer_load_dwordx4 v[160:163], v8, s[48:51], s39 offen offset:0 nt
    v_perm_b32 v56, v38, v38, v20
    v_perm_b32 v57, v38, v38, v21
    v_perm_b32 v58, v38, v38, v22
    v_perm_b32 v59, v38, v38, v23
    s_nop 0
    s_waitcnt vmcnt(23)
    v_mfma_f32_16x16x32_bf16 v[32:35], v[56:59], v[164:167], v[32:35]
    buffer_load_dwordx4 v[164:167], v8, s[48:51], s39 offen offset:1024 nt
    v_perm_b32 v52, v39, v39, v16
    v_perm_b32 v53, v39, v39, v17
    v_perm_b32 v54, v39, v39, v18
    v_perm_b32 v55, v39, v39, v19
    s_nop 0
    s_waitcnt vmcnt(23)
    v_mfma_f32_16x16x32_bf16 v[32:35], v[52:55], v[72:75], v[32:35]
    buffer_load_dwordx4 v[72:75], v8, s[48:51], s39 offen offset:2048 nt
    v_perm_b32 v56, v39, v39, v20
    v_perm_b32 v57, v39, v39, v21
    v_perm_b32 v58, v39, v39, v22
    v_perm_b32 v59, v39, v39, v23
    s_nop 0
    s_waitcnt vmcnt(23)
    v_mfma_f32_16x16x32_bf16 v[32:35], v[56:59], v[76:79], v[32:35]
    buffer_load_dwordx4 v[76:79], v8, s[48:51], s39 offen offset:3072 nt
    v_perm_b32 v52, v40, v40, v16
    v_perm_b32 v53, v40, v40, v17
    v_perm_b32 v54, v40, v40, v18
    v_perm_b32 v55, v40, v40, v19
    s_nop 0
    s_xor_b32 s39, s38, 8192
    s_waitcnt vmcnt(23)
    v_mfma_f32_16x16x32_bf16 v[32:35], v[52:55], v[80:83], v[32:35]
    buffer_load_dwordx4 v[80:83], v8, s[48:51], s39 offen offset:0 nt
    v_perm_b32 v56, v40, v40, v20
    v_perm_b32 v57, v40, v40, v21
    v_perm_b32 v58, v40, v40, v22
    v_perm_b32 v59, v40, v40, v23
    s_nop 0
    s_waitcnt vmcnt(23)
    v_mfma_f32_16x16x32_bf16 v[32:35], v[56:59], v[84:87], v[32:35]
    buffer_load_dwordx4 v[84:87], v8, s[48:51], s39 offen offset:1024 nt
    v_perm_b32 v52, v41, v41, v16
    v_perm_b32 v53, v41, v41, v17
    v_perm_b32 v54, v41, v41, v18
    v_perm_b32 v55, v41, v41, v19
    s_nop 0
    s_waitcnt vmcnt(23)
    v_mfma_f32_16x16x32_bf16 v[32:35], v[52:55], v[88:91], v[32:35]
    buffer_load_dwordx4 v[88:91], v8, s[48:51], s39 offen offset:2048 nt
    v_perm_b32 v56, v41, v41, v20
    v_perm_b32 v57, v41, v41, v21
    v_perm_b32 v58, v41, v41, v22
    v_perm_b32 v59, v41, v41, v23
    s_nop 0
    s_waitcnt vmcnt(23)
    v_mfma_f32_16x16x32_bf16 v[32:35], v[56:59], v[92:95], v[32:35]
    buffer_load_dwordx4 v[92:95], v8, s[48:51], s39 offen offset:3072 nt
    v_perm_b32 v52, v42, v42, v16
    v_perm_b32 v53, v42, v42, v17
    v_perm_b32 v54, v42, v42, v18
    v_perm_b32 v55, v42, v42, v19
    s_nop 0
    s_xor_b32 s39, s38, 12288
    s_waitcnt vmcnt(23)
    v_mfma_f32_16x16x32_bf16 v[32:35], v[52:55], v[96:99], v[32:35]
    buffer_load_dwordx4 v[96:99], v8, s[48:51], s39 offen offset:0 nt
    v_perm_b32 v56, v42, v42, v20
    v_perm_b32 v57, v42, v42, v21
    v_perm_b32 v58, v42, v42, v22
    v_perm_b32 v59, v42, v42, v23
    s_nop 0
    s_waitcnt vmcnt(23)
    v_mfma_f32_16x16x32_bf16 v[32:35], v[56:59], v[100:103], v[32:35]
    buffer_load_dwordx4 v[100:103], v8, s[48:51], s39 offen offset:1024 nt
    v_perm_b32 v52, v43, v43, v16
    v_perm_b32 v53, v43, v43, v17
    v_perm_b32 v54, v43, v43, v18
    v_perm_b32 v55, v43, v43, v19
    s_nop 0
    s_waitcnt vmcnt(23)
    v_mfma_f32_16x16x32_bf16 v[32:35], v[52:55], v[104:107], v[32:35]
    buffer_load_dwordx4 v[104:107], v8, s[48:51], s39 offen offset:2048 nt
    v_perm_b32 v56, v43, v43, v20
    v_perm_b32 v57, v43, v43, v21
    v_perm_b32 v58, v43, v43, v22
    v_perm_b32 v59, v43, v43, v23
    s_nop 0
    s_waitcnt vmcnt(23)
    v_mfma_f32_16x16x32_bf16 v[32:35], v[56:59], v[108:111], v[32:35]
    buffer_load_dwordx4 v[108:111], v8, s[48:51], s39 offen offset:3072 nt
    v_perm_b32 v52, v44, v44, v16
    v_perm_b32 v53, v44, v44, v17
    v_perm_b32 v54, v44, v44, v18
    v_perm_b32 v55, v44, v44, v19
    s_nop 0
    s_xor_b32 s39, s38, 16384
    s_waitcnt vmcnt(23)
    v_mfma_f32_16x16x32_bf16 v[32:35], v[52:55], v[112:115], v[32:35]
    buffer_load_dwordx4 v[112:115], v8, s[48:51], s39 offen offset:0 nt
    v_perm_b32 v56, v44, v44, v20
    v_perm_b32 v57, v44, v44, v21
    v_perm_b32 v58, v44, v44, v22
    v_perm_b32 v59, v44, v44, v23
    s_nop 0
    s_waitcnt vmcnt(23)
    v_mfma_f32_16x16x32_bf16 v[32:35], v[56:59], v[116:119], v[32:35]
    buffer_load_dwordx4 v[116:119], v8, s[48:51], s39 offen offset:1024 nt
    v_perm_b32 v52, v45, v45, v16
    v_perm_b32 v53, v45, v45, v17
    v_perm_b32 v54, v45, v45, v18
    v_perm_b32 v55, v45, v45, v19
    s_nop 0
    s_waitcnt vmcnt(23)
    v_mfma_f32_16x16x32_bf16 v[32:35], v[52:55], v[120:123], v[32:35]
    buffer_load_dwordx4 v[120:123], v8, s[48:51], s39 offen offset:2048 nt
    v_perm_b32 v56, v45, v45, v20
    v_perm_b32 v57, v45, v45, v21
    v_perm_b32 v58, v45, v45, v22
    v_perm_b32 v59, v45, v45, v23
    s_nop 0
    s_waitcnt vmcnt(23)
    v_mfma_f32_16x16x32_bf16 v[32:35], v[56:59], v[124:127], v[32:35]
    buffer_load_dwordx4 v[124:127], v8, s[48:51], s39 offen offset:3072 nt
    v_perm_b32 v52, v46, v46, v16
    v_perm_b32 v53, v46, v46, v17
    v_perm_b32 v54, v46, v46, v18
    v_perm_b32 v55, v46, v46, v19
    s_nop 0
    s_xor_b32 s39, s38, 20480
    s_waitcnt vmcnt(23)
    v_mfma_f32_16x16x32_bf16 v[32:35], v[52:55], v[128:131], v[32:35]
    buffer_load_dwordx4 v[128:131], v8, s[48:51], s39 offen offset:0 nt
    v_perm_b32 v56, v46, v46, v20
    v_perm_b32 v57, v46, v46, v21
    v_perm_b32 v58, v46, v46, v22
    v_perm_b32 v59, v46, v46, v23
    s_nop 0
    s_waitcnt vmcnt(23)
    v_mfma_f32_16x16x32_bf16 v[32:35], v[56:59], v[132:135], v[32:35]
    buffer_load_dwordx4 v[132:135], v8, s[48:51], s39 offen offset:1024 nt
    v_perm_b32 v52, v47, v47, v16
    v_perm_b32 v53, v47, v47, v17
    v_perm_b32 v54, v47, v47, v18
    v_perm_b32 v55, v47, v47, v19
    s_nop 0
    s_waitcnt vmcnt(23)
    v_mfma_f32_16x16x32_bf16 v[32:35], v[52:55], v[136:139], v[32:35]
    buffer_load_dwordx4 v[136:139], v8, s[48:51], s39 offen offset:2048 nt
    v_perm_b32 v56, v47, v47, v20
    v_perm_b32 v57, v47, v47, v21
    v_perm_b32 v58, v47, v47, v22
    v_perm_b32 v59, v47, v47, v23
    s_nop 0
    ds_read_b32 v9, v15 offset:860
    ds_read_b128 v[36:39], v69 offset:4096
    ds_read_b128 v[40:43], v69 offset:4112
    ds_read_b128 v[44:47], v69 offset:4128
    ds_read_b128 v[48:51], v69 offset:4144
    s_waitcnt vmcnt(23)
    v_mfma_f32_16x16x32_bf16 v[32:35], v[56:59], v[140:143], v[32:35]
    buffer_load_dwordx4 v[140:143], v8, s[48:51], s39 offen offset:3072 nt
    s_waitcnt lgkmcnt(0)
    v_cmp_gt_u32 vcc, 1, v9
    v_perm_b32 v52, v36, v36, v16
    v_perm_b32 v53, v36, v36, v17
    v_perm_b32 v54, v36, v36, v18
    v_perm_b32 v55, v36, v36, v19
    s_nop 1
    v_permlane32_swap_b32 v32, v60
    v_permlane32_swap_b32 v33, v61
    v_permlane32_swap_b32 v34, v62
    v_permlane32_swap_b32 v35, v63
    v_add_f32_dpp v32, v60, v32 row_ror:8 row_mask:0xf bank_mask:0xf
    v_add_f32_dpp v33, v61, v33 row_ror:8 row_mask:0xf bank_mask:0xf
    v_add_f32_dpp v34, v62, v34 row_ror:8 row_mask:0xf bank_mask:0xf
    v_add_f32_dpp v35, v63, v35 row_ror:8 row_mask:0xf bank_mask:0xf
    v_perm_b32 v32, v32, v7, s60
    v_perm_b32 v33, v33, v7, s61
    v_perm_b32 v34, v34, v7, s62
    v_perm_b32 v35, v35, v7, s63
    s_mov_b64 exec, 0x00ff00ff
    buffer_store_dwordx4 v[32:35], v67, s[56:59], s71 offen
    s_mov_b64 exec, -1
    v_mov_b32 v64, 112
    ds_write_b32 v1, v64 offset:1792
    s_cbranch_vccz L_pok
    s_mov_b32 s79, 0
L_pf:
    ds_read_b32 v9, v15 offset:860
    ds_read_b128 v[36:39], v69 offset:4096
    ds_read_b128 v[40:43], v69 offset:4112
    ds_read_b128 v[44:47], v69 offset:4128
    ds_read_b128 v[48:51], v69 offset:4144
    s_waitcnt lgkmcnt(0)
    v_cmp_gt_u32 vcc, 1, v9
    s_cbranch_vccz L_pf_d
    s_sleep 1
    s_add_u32 s79, s79, 1
    s_cmp_lg_u32 s79, 60
    s_cbranch_scc1 L_pf_nb
    s_cmp_lg_u32 s78, 0
    s_cbranch_scc1 L_pf_nb
    s_mov_b32 s78, 1
    s_add_u32 s70, s70, 262144
    s_add_u32 s71, s71, 262144
    s_mov_b64 exec, 0x00ff00ff
    buffer_store_dwordx4 v[28:31], v14, s[56:59], s70 offen sc1
    s_mov_b64 exec, -1
    s_mov_b64 exec, 0x00ff00ff
    buffer_store_dwordx4 v[32:35], v67, s[56:59], s71 offen sc1
    s_mov_b64 exec, -1
L_pf_nb:
    s_cmp_lt_u32 s79, 3200000
    s_cbranch_scc1 L_pf
L_pf_d:
    v_perm_b32 v52, v36, v36, v16
    v_perm_b32 v53, v36, v36, v17
    v_perm_b32 v54, v36, v36, v18
    v_perm_b32 v55, v36, v36, v19
    s_nop 1
L_pok:
    v_readfirstlane_b32 s76, v9
    s_xor_b32 s39, s38, 24576
    s_waitcnt vmcnt(23)
    v_mfma_f32_16x16x32_bf16 v[24:27], v[52:55], v[144:147], 0
    v_perm_b32 v56, v36, v36, v20
    v_perm_b32 v57, v36, v36, v21
    v_perm_b32 v58, v36, v36, v22
    v_perm_b32 v59, v36, v36, v23
    s_nop 0
    s_nop 0
    v_mfma_f32_16x16x32_bf16 v[24:27], v[56:59], v[148:151], v[24:27]
    buffer_load_dwordx4 v[144:147], v8, s[48:51], s39 offen offset:0 nt
    v_perm_b32 v52, v37, v37, v16
    v_perm_b32 v53, v37, v37, v17
    v_perm_b32 v54, v37, v37, v18
    v_perm_b32 v55, v37, v37, v19
    s_nop 0
    s_cmp_eq_u32 s76, 1
    s_cselect_b32 s65, 0, 294912
    s_add_u32 s77, s77, s65
    s_waitcnt vmcnt(23)
    v_mfma_f32_16x16x32_bf16 v[24:27], v[52:55], v[152:155], v[24:27]
    buffer_load_dwordx4 v[148:151], v8, s[48:51], s39 offen offset:1024 nt
    v_perm_b32 v56, v37, v37, v20
    v_perm_b32 v57, v37, v37, v21
    v_perm_b32 v58, v37, v37, v22
    v_perm_b32 v59, v37, v37, v23
    s_nop 0
    s_waitcnt vmcnt(23)
    v_mfma_f32_16x16x32_bf16 v[24:27], v[56:59], v[156:159], v[24:27]
    buffer_load_dwordx4 v[152:155], v8, s[48:51], s39 offen offset:2048 nt
    v_perm_b32 v52, v38, v38, v16
    v_perm_b32 v53, v38, v38, v17
    v_perm_b32 v54, v38, v38, v18
    v_perm_b32 v55, v38, v38, v19
    s_nop 0
    s_waitcnt vmcnt(23)
    v_mfma_f32_16x16x32_bf16 v[24:27], v[52:55], v[160:163], v[24:27]
    buffer_load_dwordx4 v[156:159], v8, s[48:51], s39 offen offset:3072 nt
    v_perm_b32 v56, v38, v38, v20
    v_perm_b32 v57, v38, v38, v21
    v_perm_b32 v58, v38, v38, v22
    v_perm_b32 v59, v38, v38, v23
    s_nop 0
    s_xor_b32 s39, s38, 28672
    s_waitcnt vmcnt(23)
    v_mfma_f32_16x16x32_bf16 v[24:27], v[56:59], v[164:167], v[24:27]
    buffer_load_dwordx4 v[160:163], v8, s[48:51], s39 offen offset:0 nt
    v_perm_b32 v52, v39, v39, v16
    v_perm_b32 v53, v39, v39, v17
    v_perm_b32 v54, v39, v39, v18
    v_perm_b32 v55, v39, v39, v19
    s_nop 0
    s_waitcnt vmcnt(23)
    v_mfma_f32_16x16x32_bf16 v[24:27], v[52:55], v[72:75], v[24:27]
    buffer_load_dwordx4 v[164:167], v8, s[48:51], s39 offen offset:1024 nt
    v_perm_b32 v56, v39, v39, v20
    v_perm_b32 v57, v39, v39, v21
    v_perm_b32 v58, v39, v39, v22
    v_perm_b32 v59, v39, v39, v23
    s_nop 0
    s_waitcnt vmcnt(23)
    v_mfma_f32_16x16x32_bf16 v[24:27], v[56:59], v[76:79], v[24:27]
    buffer_load_dwordx4 v[72:75], v8, s[48:51], s39 offen offset:2048 nt
    v_perm_b32 v52, v40, v40, v16
    v_perm_b32 v53, v40, v40, v17
    v_perm_b32 v54, v40, v40, v18
    v_perm_b32 v55, v40, v40, v19
    s_nop 0
    s_waitcnt vmcnt(23)
    v_mfma_f32_16x16x32_bf16 v[24:27], v[52:55], v[80:83], v[24:27]
    buffer_load_dwordx4 v[76:79], v8, s[48:51], s39 offen offset:3072 nt
    v_perm_b32 v56, v40, v40, v20
    v_perm_b32 v57, v40, v40, v21
    v_perm_b32 v58, v40, v40, v22
    v_perm_b32 v59, v40, v40, v23
    s_nop 0
    s_xor_b32 s39, s38, 32768
    s_waitcnt vmcnt(23)
    v_mfma_f32_16x16x32_bf16 v[24:27], v[56:59], v[84:87], v[24:27]
    buffer_load_dwordx4 v[80:83], v8, s[48:51], s39 offen offset:0 nt
    v_perm_b32 v52, v41, v41, v16
    v_perm_b32 v53, v41, v41, v17
    v_perm_b32 v54, v41, v41, v18
    v_perm_b32 v55, v41, v41, v19
    s_nop 0
    s_waitcnt vmcnt(23)
    v_mfma_f32_16x16x32_bf16 v[24:27], v[52:55], v[88:91], v[24:27]
    buffer_load_dwordx4 v[84:87], v8, s[48:51], s39 offen offset:1024 nt
    v_perm_b32 v56, v41, v41, v20
    v_perm_b32 v57, v41, v41, v21
    v_perm_b32 v58, v41, v41, v22
    v_perm_b32 v59, v41, v41, v23
    s_nop 0
    s_waitcnt vmcnt(23)
    v_mfma_f32_16x16x32_bf16 v[24:27], v[56:59], v[92:95], v[24:27]
    buffer_load_dwordx4 v[88:91], v8, s[48:51], s39 offen offset:2048 nt
    v_perm_b32 v52, v42, v42, v16
    v_perm_b32 v53, v42, v42, v17
    v_perm_b32 v54, v42, v42, v18
    v_perm_b32 v55, v42, v42, v19
    s_nop 0
    s_waitcnt vmcnt(23)
    v_mfma_f32_16x16x32_bf16 v[24:27], v[52:55], v[96:99], v[24:27]
    buffer_load_dwordx4 v[92:95], v8, s[48:51], s39 offen offset:3072 nt
    v_perm_b32 v56, v42, v42, v20
    v_perm_b32 v57, v42, v42, v21
    v_perm_b32 v58, v42, v42, v22
    v_perm_b32 v59, v42, v42, v23
    s_nop 0
    s_xor_b32 s39, s38, 36864
    s_waitcnt vmcnt(23)
    v_mfma_f32_16x16x32_bf16 v[24:27], v[56:59], v[100:103], v[24:27]
    buffer_load_dwordx4 v[96:99], v8, s[48:51], s39 offen offset:0 nt
    v_perm_b32 v52, v43, v43, v16
    v_perm_b32 v53, v43, v43, v17
    v_perm_b32 v54, v43, v43, v18
    v_perm_b32 v55, v43, v43, v19
    s_nop 0
    s_waitcnt vmcnt(23)
    v_mfma_f32_16x16x32_bf16 v[24:27], v[52:55], v[104:107], v[24:27]
    buffer_load_dwordx4 v[100:103], v8, s[48:51], s39 offen offset:1024 nt
    v_perm_b32 v56, v43, v43, v20
    v_perm_b32 v57, v43, v43, v21
    v_perm_b32 v58, v43, v43, v22
    v_perm_b32 v59, v43, v43, v23
    s_nop 0
    s_waitcnt vmcnt(23)
    v_mfma_f32_16x16x32_bf16 v[24:27], v[56:59], v[108:111], v[24:27]
    buffer_load_dwordx4 v[104:107], v8, s[48:51], s39 offen offset:2048 nt
    s_waitcnt lgkmcnt(0)
    v_perm_b32 v52, v44, v44, v16
    v_perm_b32 v53, v44, v44, v17
    v_perm_b32 v54, v44, v44, v18
    v_perm_b32 v55, v44, v44, v19
    s_nop 0
    ds_read_b128 v[36:39], v69 offset:4160
    ds_read_b128 v[40:43], v69 offset:4176
    s_waitcnt vmcnt(23)
    v_mfma_f32_16x16x32_bf16 v[24:27], v[52:55], v[112:115], v[24:27]
    buffer_load_dwordx4 v[108:111], v8, s[48:51], s39 offen offset:3072 nt
    v_perm_b32 v56, v44, v44, v20
    v_perm_b32 v57, v44, v44, v21
    v_perm_b32 v58, v44, v44, v22
    v_perm_b32 v59, v44, v44, v23
    s_nop 0
    s_xor_b32 s39, s38, 40960
    s_waitcnt vmcnt(23)
    v_mfma_f32_16x16x32_bf16 v[24:27], v[56:59], v[116:119], v[24:27]
    buffer_load_dwordx4 v[112:115], v8, s[48:51], s39 offen offset:0 nt
    v_perm_b32 v52, v45, v45, v16
    v_perm_b32 v53, v45, v45, v17
    v_perm_b32 v54, v45, v45, v18
    v_perm_b32 v55, v45, v45, v19
    s_nop 0
    s_waitcnt vmcnt(23)
    v_mfma_f32_16x16x32_bf16 v[24:27], v[52:55], v[120:123], v[24:27]
    buffer_load_dwordx4 v[116:119], v8, s[48:51], s39 offen offset:1024 nt
    v_perm_b32 v56, v45, v45, v20
    v_perm_b32 v57, v45, v45, v21
    v_perm_b32 v58, v45, v45, v22
    v_perm_b32 v59, v45, v45, v23
    s_nop 0
    s_waitcnt vmcnt(23)
    v_mfma_f32_16x16x32_bf16 v[24:27], v[56:59], v[124:127], v[24:27]
    buffer_load_dwordx4 v[120:123], v8, s[48:51], s39 offen offset:2048 nt
    v_perm_b32 v52, v46, v46, v16
    v_perm_b32 v53, v46, v46, v17
    v_perm_b32 v54, v46, v46, v18
    v_perm_b32 v55, v46, v46, v19
    s_nop 0
    s_waitcnt vmcnt(23)
    v_mfma_f32_16x16x32_bf16 v[24:27], v[52:55], v[128:131], v[24:27]
    buffer_load_dwordx4 v[124:127], v8, s[48:51], s39 offen offset:3072 nt
    v_perm_b32 v56, v46, v46, v20
    v_perm_b32 v57, v46, v46, v21
    v_perm_b32 v58, v46, v46, v22
    v_perm_b32 v59, v46, v46, v23
    s_nop 0
    s_xor_b32 s39, s38, 45056
    s_waitcnt vmcnt(23)
    v_mfma_f32_16x16x32_bf16 v[24:27], v[56:59], v[132:135], v[24:27]
    buffer_load_dwordx4 v[128:131], v8, s[48:51], s39 offen offset:0 nt
    v_perm_b32 v52, v47, v47, v16
    v_perm_b32 v53, v47, v47, v17
    v_perm_b32 v54, v47, v47, v18
    v_perm_b32 v55, v47, v47, v19
    s_nop 0
    s_waitcnt vmcnt(23)
    v_mfma_f32_16x16x32_bf16 v[24:27], v[52:55], v[136:139], v[24:27]
    buffer_load_dwordx4 v[132:135], v8, s[48:51], s39 offen offset:1024 nt
    v_perm_b32 v56, v47, v47, v20
    v_perm_b32 v57, v47, v47, v21
    v_perm_b32 v58, v47, v47, v22
    v_perm_b32 v59, v47, v47, v23
    s_nop 0
    s_waitcnt vmcnt(23)
    v_mfma_f32_16x16x32_bf16 v[24:27], v[56:59], v[140:143], v[24:27]
    buffer_load_dwordx4 v[136:139], v8, s[48:51], s39 offen offset:2048 nt
    v_perm_b32 v52, v48, v48, v16
    v_perm_b32 v53, v48, v48, v17
    v_perm_b32 v54, v48, v48, v18
    v_perm_b32 v55, v48, v48, v19
    s_nop 0
    s_waitcnt vmcnt(23)
    buffer_load_dwordx4 v[140:143], v8, s[48:51], s39 offen offset:3072 nt
    s_xor_b32 s39, s38, 49152
    s_waitcnt vmcnt(23)
    v_mfma_f32_16x16x32_bf16 v[24:27], v[52:55], v[144:147], v[24:27]
    buffer_load_dwordx4 v[144:147], v8, s[48:51], s39 offen offset:0 nt
    v_perm_b32 v56, v48, v48, v20
    v_perm_b32 v57, v48, v48, v21
    v_perm_b32 v58, v48, v48, v22
    v_perm_b32 v59, v48, v48, v23
    s_nop 0
    s_waitcnt vmcnt(23)
    v_mfma_f32_16x16x32_bf16 v[24:27], v[56:59], v[148:151], v[24:27]
    buffer_load_dwordx4 v[148:151], v8, s[48:51], s39 offen offset:1024 nt
    v_perm_b32 v52, v49, v49, v16
    v_perm_b32 v53, v49, v49, v17
    v_perm_b32 v54, v49, v49, v18
    v_perm_b32 v55, v49, v49, v19
    s_nop 0
    s_waitcnt vmcnt(23)
    v_mfma_f32_16x16x32_bf16 v[24:27], v[52:55], v[152:155], v[24:27]
    buffer_load_dwordx4 v[152:155], v8, s[48:51], s39 offen offset:2048 nt
    v_perm_b32 v56, v49, v49, v20
    v_perm_b32 v57, v49, v49, v21
    v_perm_b32 v58, v49, v49, v22
    v_perm_b32 v59, v49, v49, v23
    s_nop 0
    s_waitcnt vmcnt(23)
    v_mfma_f32_16x16x32_bf16 v[24:27], v[56:59], v[156:159], v[24:27]
    buffer_load_dwordx4 v[156:159], v8, s[48:51], s39 offen offset:3072 nt
    v_perm_b32 v52, v50, v50, v16
    v_perm_b32 v53, v50, v50, v17
    v_perm_b32 v54, v50, v50, v18
    v_perm_b32 v55, v50, v50, v19
    s_nop 0
    s_xor_b32 s39, s38, 53248
    s_waitcnt vmcnt(23)
    v_mfma_f32_16x16x32_bf16 v[24:27], v[52:55], v[160:163], v[24:27]
    buffer_load_dwordx4 v[160:163], v8, s[48:51], s39 offen offset:0 nt
    v_perm_b32 v56, v50, v50, v20
    v_perm_b32 v57, v50, v50, v21
    v_perm_b32 v58, v50, v50, v22
    v_perm_b32 v59, v50, v50, v23
    s_nop 0
    s_waitcnt vmcnt(23)
    v_mfma_f32_16x16x32_bf16 v[24:27], v[56:59], v[164:167], v[24:27]
    buffer_load_dwordx4 v[164:167], v8, s[48:51], s39 offen offset:1024 nt
    v_perm_b32 v52, v51, v51, v16
    v_perm_b32 v53, v51, v51, v17
    v_perm_b32 v54, v51, v51, v18
    v_perm_b32 v55, v51, v51, v19
    s_nop 0
    s_waitcnt vmcnt(23)
    v_mfma_f32_16x16x32_bf16 v[24:27], v[52:55], v[72:75], v[24:27]
    buffer_load_dwordx4 v[72:75], v8, s[48:51], s39 offen offset:2048 nt
    v_perm_b32 v56, v51, v51, v20
    v_perm_b32 v57, v51, v51, v21
    v_perm_b32 v58, v51, v51, v22
    v_perm_b32 v59, v51, v51, v23
    s_nop 0
    s_waitcnt vmcnt(23)
    v_mfma_f32_16x16x32_bf16 v[24:27], v[56:59], v[76:79], v[24:27]
    buffer_load_dwordx4 v[76:79], v8, s[48:51], s39 offen offset:3072 nt
    s_waitcnt lgkmcnt(0)
    v_perm_b32 v52, v36, v36, v16
    v_perm_b32 v53, v36, v36, v17
    v_perm_b32 v54, v36, v36, v18
    v_perm_b32 v55, v36, v36, v19
    s_nop 0
    ds_read_b128 v[44:47], v69 offset:4192
    ds_read_b128 v[48:51], v69 offset:4208
    s_xor_b32 s39, s38, 57344
    s_waitcnt vmcnt(23)
    v_mfma_f32_16x16x32_bf16 v[24:27], v[52:55], v[80:83], v[24:27]
    buffer_load_dwordx4 v[80:83], v8, s[48:51], s39 offen offset:0 nt
    v_perm_b32 v56, v36, v36, v20
    v_perm_b32 v57, v36, v36, v21
    v_perm_b32 v58, v36, v36, v22
    v_perm_b32 v59, v36, v36, v23
    s_nop 0
    s_waitcnt vmcnt(23)
    v_mfma_f32_16x16x32_bf16 v[24:27], v[56:59], v[84:87], v[24:27]
    buffer_load_dwordx4 v[84:87], v8, s[48:51], s39 offen offset:1024 nt
    v_perm_b32 v52, v37, v37, v16
    v_perm_b32 v53, v37, v37, v17
    v_perm_b32 v54, v37, v37, v18
    v_perm_b32 v55, v37, v37, v19
    s_nop 0
    s_waitcnt vmcnt(23)
    v_mfma_f32_16x16x32_bf16 v[24:27], v[52:55], v[88:91], v[24:27]
    buffer_load_dwordx4 v[88:91], v8, s[48:51], s39 offen offset:2048 nt
    v_perm_b32 v56, v37, v37, v20
    v_perm_b32 v57, v37, v37, v21
    v_perm_b32 v58, v37, v37, v22
    v_perm_b32 v59, v37, v37, v23
    s_nop 0
    s_waitcnt vmcnt(23)
    v_mfma_f32_16x16x32_bf16 v[24:27], v[56:59], v[92:95], v[24:27]
    buffer_load_dwordx4 v[92:95], v8, s[48:51], s39 offen offset:3072 nt
    v_perm_b32 v52, v38, v38, v16
    v_perm_b32 v53, v38, v38, v17
    v_perm_b32 v54, v38, v38, v18
    v_perm_b32 v55, v38, v38, v19
    s_nop 0
    s_xor_b32 s39, s38, 61440
    s_waitcnt vmcnt(23)
    v_mfma_f32_16x16x32_bf16 v[24:27], v[52:55], v[96:99], v[24:27]
    buffer_load_dwordx4 v[96:99], v8, s[48:51], s39 offen offset:0 nt
    v_perm_b32 v56, v38, v38, v20
    v_perm_b32 v57, v38, v38, v21
    v_perm_b32 v58, v38, v38, v22
    v_perm_b32 v59, v38, v38, v23
    s_nop 0
    s_waitcnt vmcnt(23)
    v_mfma_f32_16x16x32_bf16 v[24:27], v[56:59], v[100:103], v[24:27]
    buffer_load_dwordx4 v[100:103], v8, s[48:51], s39 offen offset:1024 nt
    v_perm_b32 v52, v39, v39, v16
    v_perm_b32 v53, v39, v39, v17
    v_perm_b32 v54, v39, v39, v18
    v_perm_b32 v55, v39, v39, v19
    s_nop 0
    s_waitcnt vmcnt(23)
    v_mfma_f32_16x16x32_bf16 v[24:27], v[52:55], v[104:107], v[24:27]
    buffer_load_dwordx4 v[104:107], v8, s[48:51], s39 offen offset:2048 nt
    v_perm_b32 v56, v39, v39, v20
    v_perm_b32 v57, v39, v39, v21
    v_perm_b32 v58, v39, v39, v22
    v_perm_b32 v59, v39, v39, v23
    s_nop 0
    s_waitcnt vmcnt(23)
    v_mfma_f32_16x16x32_bf16 v[24:27], v[56:59], v[108:111], v[24:27]
    buffer_load_dwordx4 v[108:111], v8, s[48:51], s39 offen offset:3072 nt
    v_perm_b32 v52, v40, v40, v16
    v_perm_b32 v53, v40, v40, v17
    v_perm_b32 v54, v40, v40, v18
    v_perm_b32 v55, v40, v40, v19
    s_nop 0
    s_mov_b64 s[40:41], s[24:25]
    s_mov_b32 s42, 5308416
    s_mov_b32 s43, 0x20000
    s_mul_i32 s39, s4, 20736
    v_mov_b32 v10, 0x7fff0000
    v_cmp_gt_u32 vcc, 16, v2
    s_nop 1
    v_cndmask_b32 v68, v10, v8, vcc
    s_mov_b32 m0, 23552
    s_nop 0
    buffer_load_dwordx4 v8, s[40:43], s39 offen offset:0 nt lds
    buffer_load_dwordx4 v8, s[40:43], s39 offen offset:1024 nt lds
    buffer_load_dwordx4 v8, s[40:43], s39 offen offset:2048 nt lds
    buffer_load_dwordx4 v8, s[40:43], s39 offen offset:3072 nt lds
    s_add_u32 s39, s39, 4096
    s_mov_b32 m0, 27648
    s_nop 0
    buffer_load_dwordx4 v8, s[40:43], s39 offen offset:0 nt lds
    buffer_load_dwordx4 v8, s[40:43], s39 offen offset:1024 nt lds
    buffer_load_dwordx4 v8, s[40:43], s39 offen offset:2048 nt lds
    buffer_load_dwordx4 v8, s[40:43], s39 offen offset:3072 nt lds
    s_add_u32 s39, s39, 4096
    s_mov_b32 m0, 31744
    s_waitcnt vmcnt(31)
    v_mfma_f32_16x16x32_bf16 v[24:27], v[52:55], v[112:115], v[24:27]
    buffer_load_dwordx4 v8, s[40:43], s39 offen offset:0 nt lds
    v_perm_b32 v56, v40, v40, v20
    v_perm_b32 v57, v40, v40, v21
    v_perm_b32 v58, v40, v40, v22
    v_perm_b32 v59, v40, v40, v23
    s_nop 0
    s_waitcnt vmcnt(31)
    v_mfma_f32_16x16x32_bf16 v[24:27], v[56:59], v[116:119], v[24:27]
    buffer_load_dwordx4 v8, s[40:43], s39 offen offset:1024 nt lds
    v_perm_b32 v52, v41, v41, v16
    v_perm_b32 v53, v41, v41, v17
    v_perm_b32 v54, v41, v41, v18
    v_perm_b32 v55, v41, v41, v19
    s_nop 0
    s_waitcnt vmcnt(31)
    v_mfma_f32_16x16x32_bf16 v[24:27], v[52:55], v[120:123], v[24:27]
    buffer_load_dwordx4 v8, s[40:43], s39 offen offset:2048 nt lds
    v_perm_b32 v56, v41, v41, v20
    v_perm_b32 v57, v41, v41, v21
    v_perm_b32 v58, v41, v41, v22
    v_perm_b32 v59, v41, v41, v23
    s_nop 0
    s_waitcnt vmcnt(31)
    v_mfma_f32_16x16x32_bf16 v[24:27], v[56:59], v[124:127], v[24:27]
    buffer_load_dwordx4 v8, s[40:43], s39 offen offset:3072 nt lds
    v_perm_b32 v52, v42, v42, v16
    v_perm_b32 v53, v42, v42, v17
    v_perm_b32 v54, v42, v42, v18
    v_perm_b32 v55, v42, v42, v19
    s_nop 0
    s_add_u32 s39, s39, 4096
    s_mov_b32 m0, 35840
    s_waitcnt vmcnt(31)
    v_mfma_f32_16x16x32_bf16 v[24:27], v[52:55], v[128:131], v[24:27]
    buffer_load_dwordx4 v8, s[40:43], s39 offen offset:0 nt lds
    v_perm_b32 v56, v42, v42, v20
    v_perm_b32 v57, v42, v42, v21
    v_perm_b32 v58, v42, v42, v22
    v_perm_b32 v59, v42, v42, v23
    s_nop 0
    s_waitcnt vmcnt(31)
    v_mfma_f32_16x16x32_bf16 v[24:27], v[56:59], v[132:135], v[24:27]
    buffer_load_dwordx4 v8, s[40:43], s39 offen offset:1024 nt lds
    v_perm_b32 v52, v43, v43, v16
    v_perm_b32 v53, v43, v43, v17
    v_perm_b32 v54, v43, v43, v18
    v_perm_b32 v55, v43, v43, v19
    s_nop 0
    s_waitcnt vmcnt(31)
    v_mfma_f32_16x16x32_bf16 v[24:27], v[52:55], v[136:139], v[24:27]
    buffer_load_dwordx4 v8, s[40:43], s39 offen offset:2048 nt lds
    v_perm_b32 v56, v43, v43, v20
    v_perm_b32 v57, v43, v43, v21
    v_perm_b32 v58, v43, v43, v22
    v_perm_b32 v59, v43, v43, v23
    s_nop 0
    s_waitcnt vmcnt(31)
    v_mfma_f32_16x16x32_bf16 v[24:27], v[56:59], v[140:143], v[24:27]
    buffer_load_dwordx4 v8, s[40:43], s39 offen offset:3072 nt lds
    s_waitcnt lgkmcnt(0)
    v_perm_b32 v52, v44, v44, v16
    v_perm_b32 v53, v44, v44, v17
    v_perm_b32 v54, v44, v44, v18
    v_perm_b32 v55, v44, v44, v19
    s_nop 0
    s_add_u32 s39, s39, 4096
    s_mov_b32 m0, 39936
    s_waitcnt vmcnt(31)
    v_mfma_f32_16x16x32_bf16 v[24:27], v[52:55], v[144:147], v[24:27]
    buffer_load_dwordx4 v8, s[40:43], s39 offen offset:0 nt lds
    v_perm_b32 v56, v44, v44, v20
    v_perm_b32 v57, v44, v44, v21
    v_perm_b32 v58, v44, v44, v22
    v_perm_b32 v59, v44, v44, v23
    s_nop 0
    s_waitcnt vmcnt(31)
    v_mfma_f32_16x16x32_bf16 v[24:27], v[56:59], v[148:151], v[24:27]
    buffer_load_dwordx4 v8, s[40:43], s39 offen offset:1024 nt lds
    v_perm_b32 v52, v45, v45, v16
    v_perm_b32 v53, v45, v45, v17
    v_perm_b32 v54, v45, v45, v18
    v_perm_b32 v55, v45, v45, v19
    s_nop 0
    s_waitcnt vmcnt(31)
    v_mfma_f32_16x16x32_bf16 v[24:27], v[52:55], v[152:155], v[24:27]
    buffer_load_dwordx4 v8, s[40:43], s39 offen offset:2048 nt lds
    v_perm_b32 v56, v45, v45, v20
    v_perm_b32 v57, v45, v45, v21
    v_perm_b32 v58, v45, v45, v22
    v_perm_b32 v59, v45, v45, v23
    s_nop 0
    s_waitcnt vmcnt(31)
    v_mfma_f32_16x16x32_bf16 v[24:27], v[56:59], v[156:159], v[24:27]
    buffer_load_dwordx4 v8, s[40:43], s39 offen offset:3072 nt lds
    v_perm_b32 v52, v46, v46, v16
    v_perm_b32 v53, v46, v46, v17
    v_perm_b32 v54, v46, v46, v18
    v_perm_b32 v55, v46, v46, v19
    s_nop 0
    s_add_u32 s39, s39, 4096
    s_mov_b32 m0, 44032
    s_waitcnt vmcnt(31)
    v_mfma_f32_16x16x32_bf16 v[24:27], v[52:55], v[160:163], v[24:27]
    buffer_load_dwordx4 v68, s[40:43], s39 offen offset:0 nt lds
    v_perm_b32 v56, v46, v46, v20
    v_perm_b32 v57, v46, v46, v21
    v_perm_b32 v58, v46, v46, v22
    v_perm_b32 v59, v46, v46, v23
    s_nop 0
    s_mov_b64 s[40:41], s[16:17]
    s_mov_b32 s42, 4718592
    s_mov_b32 s43, 0x20000
    s_lshl_b32 s39, s35, 4
    s_add_u32 s39, s39, s36
    s_mul_i32 s39, s39, 18432
    s_mov_b32 m0, 5120
    s_waitcnt vmcnt(31)
    v_mfma_f32_16x16x32_bf16 v[24:27], v[56:59], v[164:167], v[24:27]
    buffer_load_dwordx4 v8, s[40:43], s39 offen offset:0 nt lds
    v_perm_b32 v52, v47, v47, v16
    v_perm_b32 v53, v47, v47, v17
    v_perm_b32 v54, v47, v47, v18
    v_perm_b32 v55, v47, v47, v19
    s_nop 0
    s_waitcnt vmcnt(31)
    v_mfma_f32_16x16x32_bf16 v[24:27], v[52:55], v[72:75], v[24:27]
    buffer_load_dwordx4 v8, s[40:43], s39 offen offset:1024 nt lds
    v_perm_b32 v56, v47, v47, v20
    v_perm_b32 v57, v47, v47, v21
    v_perm_b32 v58, v47, v47, v22
    v_perm_b32 v59, v47, v47, v23
    s_nop 0
    s_waitcnt vmcnt(31)
    v_mfma_f32_16x16x32_bf16 v[24:27], v[56:59], v[76:79], v[24:27]
    buffer_load_dwordx4 v8, s[40:43], s39 offen offset:2048 nt lds
    v_perm_b32 v52, v48, v48, v16
    v_perm_b32 v53, v48, v48, v17
    v_perm_b32 v54, v48, v48, v18
    v_perm_b32 v55, v48, v48, v19
    s_nop 0
    s_waitcnt vmcnt(31)
    v_mfma_f32_16x16x32_bf16 v[24:27], v[52:55], v[80:83], v[24:27]
    buffer_load_dwordx4 v8, s[40:43], s39 offen offset:3072 nt lds
    v_perm_b32 v56, v48, v48, v20
    v_perm_b32 v57, v48, v48, v21
    v_perm_b32 v58, v48, v48, v22
    v_perm_b32 v59, v48, v48, v23
    s_nop 0
    s_add_u32 s39, s39, 4096
    s_mov_b32 m0, 9216
    s_waitcnt vmcnt(31)
    v_mfma_f32_16x16x32_bf16 v[24:27], v[56:59], v[84:87], v[24:27]
    buffer_load_dwordx4 v8, s[40:43], s39 offen offset:0 nt lds
    v_perm_b32 v52, v49, v49, v16
    v_perm_b32 v53, v49, v49, v17
    v_perm_b32 v54, v49, v49, v18
    v_perm_b32 v55, v49, v49, v19
    s_nop 0
    s_waitcnt vmcnt(31)
    v_mfma_f32_16x16x32_bf16 v[24:27], v[52:55], v[88:91], v[24:27]
    buffer_load_dwordx4 v8, s[40:43], s39 offen offset:1024 nt lds
    v_perm_b32 v56, v49, v49, v20
    v_perm_b32 v57, v49, v49, v21
    v_perm_b32 v58, v49, v49, v22
    v_perm_b32 v59, v49, v49, v23
    s_nop 0
    s_waitcnt vmcnt(31)
    v_mfma_f32_16x16x32_bf16 v[24:27], v[56:59], v[92:95], v[24:27]
    buffer_load_dwordx4 v8, s[40:43], s39 offen offset:2048 nt lds
    v_perm_b32 v52, v50, v50, v16
    v_perm_b32 v53, v50, v50, v17
    v_perm_b32 v54, v50, v50, v18
    v_perm_b32 v55, v50, v50, v19
    s_nop 0
    s_waitcnt vmcnt(31)
    v_mfma_f32_16x16x32_bf16 v[24:27], v[52:55], v[96:99], v[24:27]
    buffer_load_dwordx4 v8, s[40:43], s39 offen offset:3072 nt lds
    v_perm_b32 v56, v50, v50, v20
    v_perm_b32 v57, v50, v50, v21
    v_perm_b32 v58, v50, v50, v22
    v_perm_b32 v59, v50, v50, v23
    s_nop 0
    s_add_u32 s39, s39, 4096
    s_mov_b32 m0, 13312
    s_waitcnt vmcnt(31)
    v_mfma_f32_16x16x32_bf16 v[24:27], v[56:59], v[100:103], v[24:27]
    buffer_load_dwordx4 v8, s[40:43], s39 offen offset:0 nt lds
    v_perm_b32 v52, v51, v51, v16
    v_perm_b32 v53, v51, v51, v17
    v_perm_b32 v54, v51, v51, v18
    v_perm_b32 v55, v51, v51, v19
    s_nop 0
    s_waitcnt vmcnt(31)
    v_mfma_f32_16x16x32_bf16 v[24:27], v[52:55], v[104:107], v[24:27]
    buffer_load_dwordx4 v8, s[40:43], s39 offen offset:1024 nt lds
    v_perm_b32 v56, v51, v51, v20
    v_perm_b32 v57, v51, v51, v21
    v_perm_b32 v58, v51, v51, v22
    v_perm_b32 v59, v51, v51, v23
    s_nop 0
    s_waitcnt vmcnt(31)
    v_mfma_f32_16x16x32_bf16 v[24:27], v[56:59], v[108:111], v[24:27]
    v_mov_b32 v64, 176
    ds_write_b32 v1, v64 offset:1792
    s_cmp_eq_u32 s76, 1
    s_nop 6
    v_perm_b32 v24, v24, v7, s60
    v_perm_b32 v25, v25, v7, s61
    v_perm_b32 v26, v26, v7, s62
    v_perm_b32 v27, v27, v7, s63
    s_cbranch_scc0 L_os_b
    buffer_store_dwordx4 v[24:27], v8, s[56:59], s77 offen
    s_branch L_os_d
L_os_b:
    buffer_store_dwordx4 v[24:27], v8, s[56:59], s77 offen sc1
L_os_d:
    buffer_load_dwordx4 v8, s[40:43], s39 offen offset:2048 nt lds
    s_waitcnt vmcnt(31)
    buffer_load_dwordx4 v8, s[40:43], s39 offen offset:3072 nt lds
    s_add_u32 s39, s39, 4096
    s_mov_b32 m0, 17408
    s_waitcnt vmcnt(31)
    buffer_load_dwordx4 v8, s[40:43], s39 offen offset:0 nt lds
    s_waitcnt vmcnt(31)
    buffer_load_dwordx4 v8, s[40:43], s39 offen offset:1024 nt lds
    s_waitcnt vmcnt(31)
    buffer_load_dwordx4 v8, s[40:43], s39 offen offset:2048 nt lds
    s_waitcnt vmcnt(31)
    buffer_load_dwordx4 v8, s[40:43], s39 offen offset:3072 nt lds
    s_add_u32 s39, s39, 4096
    s_mov_b32 m0, 21504
    s_waitcnt vmcnt(31)
    buffer_load_dwordx4 v8, s[40:43], s39 offen offset:0 nt lds
    s_waitcnt vmcnt(31)
    buffer_load_dwordx4 v8, s[40:43], s39 offen offset:1024 nt lds
    s_waitcnt vmcnt(19)
    s_nop 0
    v_mov_b32 v64, 197
    ds_write_b32 v1, v64 offset:1792
    ds_read_b32 v9, v15 offset:864
    s_waitcnt lgkmcnt(0)
    v_cmp_ne_u32 vcc, 1, v9
    s_cbranch_vccz L_ld_end
    s_cmp_lg_u32 s78, 0
    s_cbranch_scc1 L_ld_end
    s_mov_b32 s78, 1
    s_add_u32 s70, s70, 262144
    s_add_u32 s71, s71, 262144
    s_mov_b64 exec, 0x00ff00ff
    buffer_store_dwordx4 v[28:31], v14, s[56:59], s70 offen sc1
    s_mov_b64 exec, -1
    s_mov_b64 exec, 0x00ff00ff
    buffer_store_dwordx4 v[32:35], v67, s[56:59], s71 offen sc1
    s_mov_b64 exec, -1
L_ld_end:
    s_waitcnt vmcnt(0)
    s_barrier
    s_endpgm
L_pwave:
    s_setprio 2
    s_waitcnt lgkmcnt(0)
    s_load_dword s34, s[32:33], 0
    s_mov_b64 s[56:57], s[32:33]
    s_mov_b32 s58, 536870912
    s_mov_b32 s59, 0x20000
    s_mov_b32 s60, 0x07060500
    s_mov_b32 s61, 0x07060501
    s_mov_b32 s62, 0x07060502
    s_mov_b32 s63, 0x07060503
    s_mov_b32 s64, 0x0c0c0400
    s_lshl_b32 s76, s35, 12
    s_add_u32 s76, s76, 65536
    s_xor_b32 s39, s76, 0x1000
    v_lshlrev_b32 v9, 7, v4
    v_lshl_add_u32 v9, v6, 4, v9
    v_and_b32 v10, 8, v2
    v_add_u32 v13, v9, v10
    v_lshrrev_b32 v9, 5, v2
    v_and_b32 v11, 3, v2
    v_lshlrev_b32 v10, 6, v9
    v_lshl_add_u32 v19, v11, 4, v10
    v_lshrrev_b32 v10, 2, v2
    v_mul_u32_u24 v10, 1152, v10
    v_lshl_add_u32 v21, v11, 4, v10
    v_and_b32 v12, 1, v2
    v_lshl_add_u32 v20, v12, 4, v10
    v_bfe_u32 v9, v2, 1, 1
    v_lshl_add_u32 v20, v9, 8, v20
    v_lshl_add_u32 v14, v9, 2, v4
    v_lshl_add_u32 v14, v12, 3, v14
    v_lshlrev_b32 v14, 1, v14
    v_lshlrev_b32 v22, 5, v2
    v_lshlrev_b32 v23, 8, v2
    s_mul_i32 s75, s35, 18432
    s_add_u32 s75, s75, 524288
    s_mul_i32 s77, s36, 1152
    s_add_u32 s77, s77, s75
    s_lshr_b32 s74, s36, 3
    s_lshl_b32 s78, s74, 9
    s_and_b32 s65, s36, 7
    s_lshl_b32 s65, s65, 5
    s_add_u32 s78, s78, s65
    v_sub_u32 v18, v20, v10
    v_add_u32 v18, s78, v18
    s_lshl_b32 s65, s36, 2
    s_lshl_b64 s[40:41], 15, s65
    s_add_u32 s78, s78, s75
    s_lshl_b32 s74, s74, 6
    s_add_u32 s74, s74, s75
    s_add_u32 s74, s74, 1024
    v_mov_b32 v24, 0
    v_mov_b32 v25, 0
    v_mov_b32 v26, 0
    v_mov_b32 v27, 0
    s_mov_b64 exec, 0xff
    buffer_store_dwordx4 v[24:27], v8, s[56:59], s77 offen offset:1024
    s_mov_b64 exec, -1
    s_getreg_b32 s6, hwreg(HW_REG_XCC_ID)
    s_and_b32 s6, s6, 15
    s_lshl_b32 s6, s6, 8
    s_movk_i32 s7, 0xf00
    v_mov_b32 v0, s6
    s_waitcnt lgkmcnt(0)
    s_add_u32 s34, s34, 0x01010101
    s_cmp_eq_u32 s34, 0
    s_cselect_b32 s34, 0x01010101, s34
    v_mov_b32 v7, s34
    s_barrier
    v_not_b32 v96, v7
    s_mov_b64 s[66:67], -1
    v_not_b32 v100, v7
    s_mov_b64 s[68:69], -1
    v_not_b32 v104, v7
    s_mov_b64 s[70:71], -1
    v_not_b32 v108, v7
    s_mov_b64 s[72:73], -1
    s_mov_b32 s79, 0
    s_sleep 25
L_q_loop:
    s_mov_b64 exec, s[66:67]
    s_cbranch_execz L_q_s0
    buffer_load_dwordx4 v[96:99], v8, s[56:59], s76 offen offset:0 sc1
L_q_s0:
    s_mov_b64 exec, s[68:69]
    s_cbranch_execz L_q_s1
    buffer_load_dwordx4 v[100:103], v8, s[56:59], s76 offen offset:1024 sc1
L_q_s1:
    s_mov_b64 exec, s[70:71]
    s_cbranch_execz L_q_s2
    buffer_load_dwordx4 v[104:107], v8, s[56:59], s76 offen offset:2048 sc1
L_q_s2:
    s_mov_b64 exec, s[72:73]
    s_cbranch_execz L_q_s3
    buffer_load_dwordx4 v[108:111], v8, s[56:59], s76 offen offset:3072 sc1
L_q_s3:
    s_mov_b64 exec, -1
    s_waitcnt vmcnt(0)
    v_perm_b32 v44, v97, v96, s64
    v_perm_b32 v45, v99, v98, s64
    v_lshl_or_b32 v44, v45, 16, v44
    v_perm_b32 v46, v101, v100, s64
    v_perm_b32 v47, v103, v102, s64
    v_lshl_or_b32 v46, v47, 16, v46
    v_perm_b32 v48, v105, v104, s64
    v_perm_b32 v49, v107, v106, s64
    v_lshl_or_b32 v48, v49, 16, v48
    v_perm_b32 v50, v109, v108, s64
    v_perm_b32 v51, v111, v110, s64
    v_lshl_or_b32 v50, v51, 16, v50
    v_cmp_ne_u32 s[66:67], v44, v7
    v_cmp_ne_u32 s[68:69], v46, v7
    v_cmp_ne_u32 s[70:71], v48, v7
    v_cmp_ne_u32 s[72:73], v50, v7
    s_or_b64 vcc, s[66:67], s[68:69]
    s_or_b64 vcc, vcc, s[70:71]
    s_or_b64 vcc, vcc, s[72:73]
    s_cbranch_scc0 L_q_done
    s_add_u32 s79, s79, 1
    s_cmp_lt_u32 s79, 12
    s_cbranch_scc1 L_q_loop
    s_waitcnt vmcnt(0)
    v_perm_b32 v44, v97, v96, s64
    v_perm_b32 v45, v99, v98, s64
    v_lshl_or_b32 v44, v45, 16, v44
    v_perm_b32 v46, v101, v100, s64
    v_perm_b32 v47, v103, v102, s64
    v_lshl_or_b32 v46, v47, 16, v46
    v_perm_b32 v48, v105, v104, s64
    v_perm_b32 v49, v107, v106, s64
    v_lshl_or_b32 v48, v49, 16, v48
    v_perm_b32 v50, v109, v108, s64
    v_perm_b32 v51, v111, v110, s64
    v_lshl_or_b32 v50, v51, 16, v50
    v_cmp_ne_u32 s[66:67], v44, v7
    v_cmp_ne_u32 s[68:69], v46, v7
    v_cmp_ne_u32 s[70:71], v48, v7
    v_cmp_ne_u32 s[72:73], v50, v7
    s_or_b64 vcc, s[66:67], s[68:69]
    s_or_b64 vcc, vcc, s[70:71]
    s_or_b64 vcc, vcc, s[72:73]
    s_cbranch_scc0 L_q_done
    s_xor_b32 s76, s76, 262144
    s_cmp_lt_u32 s79, 800000
    s_cbranch_scc1 L_q_loop
L_q_done:
    v_and_b32 v128, 0xffffff00, v96
    v_and_b32 v129, 0xffffff00, v97
    v_and_b32 v130, 0xffffff00, v98
    v_and_b32 v131, 0xfffff000, v99
    v_and_b32 v132, 0xffffff00, v100
    v_and_b32 v133, 0xffffff00, v101
    v_and_b32 v134, 0xffffff00, v102
    v_and_b32 v135, 0xfffff000, v103
    v_and_b32 v136, 0xffffff00, v104
    v_and_b32 v137, 0xffffff00, v105
    v_and_b32 v138, 0xffffff00, v106
    v_and_b32 v139, 0xfffff000, v107
    v_and_b32 v140, 0xffffff00, v108
    v_and_b32 v141, 0xffffff00, v109
    v_and_b32 v142, 0xffffff00, v110
    v_and_b32 v143, 0xfffff000, v111
    v_pk_add_f32 v[32:33], v[128:129], v[132:133]
    v_pk_add_f32 v[34:35], v[130:131], v[134:135]
    v_pk_add_f32 v[36:37], v[136:137], v[140:141]
    v_pk_add_f32 v[38:39], v[138:139], v[142:143]
    v_pk_add_f32 v[32:33], v[32:33], v[36:37]
    v_pk_add_f32 v[34:35], v[34:35], v[38:39]
    v_cvt_pk_bf16_f32 v36, v32, v33
    v_cvt_pk_bf16_f32 v37, v34, v35
    v_mov_b32 v10, 1
    ds_write_b64 v13, v[36:37] offset:0
    s_mov_b64 exec, 1
    ds_write_b32 v15, v10 offset:848
    s_mov_b64 exec, -1
    v_not_b32 v120, v7
    s_mov_b64 exec, 0xffff
    buffer_load_dwordx4 v[120:123], v23, s[56:59], s39 offen sc1
    s_mov_b64 exec, -1
    v_xor_b32 v44, v99, v0
    v_xor_b32 v45, v103, v0
    v_xor_b32 v46, v107, v0
    v_xor_b32 v47, v111, v0
    v_or3_b32 v44, v44, v45, v46
    v_or_b32 v44, v44, v47
    v_and_b32 v44, s7, v44
    v_cmp_ne_u32 vcc, 0, v44
    s_cmp_lg_u64 vcc, 0
    s_cselect_b32 s38, 294912, 0
    s_cselect_b32 s37, 2, 1
    s_add_u32 s74, s74, s38
    s_add_u32 s77, s77, s38
    s_add_u32 s78, s78, s38
    v_mov_b32 v11, s37
    v_mov_b32 v12, 0x3e0293ee
    s_mov_b32 s79, 0
L_c2a:
    ds_read_b32 v9, v15 offset:856
    s_waitcnt lgkmcnt(0)
    v_cmp_gt_u32 vcc, 7, v9
    s_cbranch_vccz L_c2a_d
    s_sleep 2
    s_add_u32 s79, s79, 1
    s_cmp_lt_u32 s79, 3200000
    s_cbranch_scc1 L_c2a
L_c2a_d:
    s_mov_b32 s79, 0
L_c2:
    ds_read_b32 v9, v15 offset:856
    ds_read_b128 v[48:51], v22 offset:2048
    ds_read_b128 v[52:55], v22 offset:2064
    s_waitcnt lgkmcnt(0)
    v_cmp_gt_u32 vcc, 9, v9
    s_cbranch_vccz L_c2_d
    s_add_u32 s79, s79, 1
    s_cmp_lt_u32 s79, 3200000
    s_cbranch_scc1 L_c2
L_c2_d:
    v_max3_f32 v62, v48, v49, v50
    v_max3_f32 v63, v51, v52, v53
    v_max3_f32 v62, v62, v54, v55
    v_max_f32 v62, v62, v63
    s_nop 1
    v_max_f32_dpp v62, v62, v62 row_ror:8 row_mask:0xf bank_mask:0xf
    s_nop 1
    v_max_f32_dpp v62, v62, v62 row_ror:4 row_mask:0xf bank_mask:0xf
    s_nop 1
    v_max_f32_dpp v62, v62, v62 row_ror:2 row_mask:0xf bank_mask:0xf
    s_nop 1
    v_max_f32_dpp v62, v62, v62 row_ror:1 row_mask:0xf bank_mask:0xf
    v_mov_b32 v63, v62
    s_nop 1
    v_permlane16_swap_b32 v63, v62
    v_max_f32 v62, v62, v63
    v_mul_f32 v62, v12, v62
    v_and_b32 v62, 0xffffff00, v62
    v_fma_f32 v48, v48, v12, -v62
    v_fma_f32 v49, v49, v12, -v62
    v_fma_f32 v50, v50, v12, -v62
    v_fma_f32 v51, v51, v12, -v62
    v_fma_f32 v52, v52, v12, -v62
    v_fma_f32 v53, v53, v12, -v62
    v_fma_f32 v54, v54, v12, -v62
    v_fma_f32 v55, v55, v12, -v62
    v_exp_f32 v48, v48
    v_exp_f32 v49, v49
    v_exp_f32 v50, v50
    v_exp_f32 v51, v51
    v_exp_f32 v52, v52
    v_exp_f32 v53, v53
    v_exp_f32 v54, v54
    v_exp_f32 v55, v55
    v_cvt_pk_bf16_f32 v44, v48, v49
    v_cvt_pk_bf16_f32 v45, v50, v51
    v_cvt_pk_bf16_f32 v46, v52, v53
    v_cvt_pk_bf16_f32 v47, v54, v55
    ds_write_b128 v8, v[44:47] offset:4096
    s_mov_b64 exec, 1
    ds_write_b32 v15, v11 offset:860
    s_mov_b64 exec, -1
    ds_read_b32 v17, v15 offset:832
    v_pk_add_f32 v[48:49], v[48:49], v[52:53]
    v_pk_add_f32 v[50:51], v[50:51], v[54:55]
    v_pk_add_f32 v[48:49], v[48:49], v[50:51]
    v_add_f32 v48, v48, v49
    s_nop 1
    v_add_f32_dpp v48, v48, v48 row_ror:8 row_mask:0xf bank_mask:0xf
    s_nop 1
    v_add_f32_dpp v48, v48, v48 row_ror:4 row_mask:0xf bank_mask:0xf
    s_nop 1
    v_add_f32_dpp v48, v48, v48 row_ror:2 row_mask:0xf bank_mask:0xf
    s_nop 1
    v_add_f32_dpp v48, v48, v48 row_ror:1 row_mask:0xf bank_mask:0xf
    v_mov_b32 v49, v48
    s_nop 1
    v_permlane16_swap_b32 v49, v48
    v_add_f32 v48, v48, v49
    v_perm_b32 v40, v62, v7, s60
    v_perm_b32 v41, v48, v7, s61
    v_perm_b32 v42, v40, v7, s62
    v_perm_b32 v43, v40, v7, s63
    s_mov_b32 exec_lo, 0xf
    s_mov_b32 exec_hi, 0xf
    s_cmp_eq_u32 s38, 0
    s_cbranch_scc0 L_ss_b
    buffer_store_dwordx4 v[40:43], v19, s[56:59], s77 offen offset:1024
    s_branch L_ss_d
L_ss_b:
    buffer_store_dwordx4 v[40:43], v19, s[56:59], s77 offen offset:1024 sc1
L_ss_d:
    s_mov_b64 exec, 0xffff
    s_cmp_lg_u32 s38, 0
    s_cbranch_scc1 L_sib_fail
    s_mov_b64 s[66:67], 0xffff
    s_mov_b32 s79, 0
    v_perm_b32 v64, v121, v120, s64
    v_perm_b32 v65, v123, v122, s64
    v_lshl_or_b32 v64, v65, 16, v64
    v_cmp_ne_u32 s[66:67], v64, v7
    s_cmp_eq_u64 s[66:67], 0
    s_cbranch_scc1 L_sib_done
L_sib_loop:
    s_mov_b64 exec, s[66:67]
    buffer_load_dwordx4 v[120:123], v23, s[56:59], s39 offen sc1
    s_mov_b64 exec, 0xffff
    s_sleep 4
    v_perm_b32 v64, v121, v120, s64
    v_perm_b32 v65, v123, v122, s64
    v_lshl_or_b32 v64, v65, 16, v64
    v_cmp_ne_u32 s[66:67], v64, v7
    s_cmp_eq_u64 s[66:67], 0
    s_cbranch_scc1 L_sib_done
    s_sleep 4
    v_perm_b32 v64, v121, v120, s64
    v_perm_b32 v65, v123, v122, s64
    v_lshl_or_b32 v64, v65, 16, v64
    v_cmp_ne_u32 s[66:67], v64, v7
    s_cmp_eq_u64 s[66:67], 0
    s_cbranch_scc1 L_sib_done
    s_sleep 4
    v_perm_b32 v64, v121, v120, s64
    v_perm_b32 v65, v123, v122, s64
    v_lshl_or_b32 v64, v65, 16, v64
    v_cmp_ne_u32 s[66:67], v64, v7
    s_cmp_eq_u64 s[66:67], 0
    s_cbranch_scc1 L_sib_done
    s_waitcnt vmcnt(24)
    s_add_u32 s79, s79, 1
    s_cmp_lt_u32 s79, 4
    s_cbranch_scc1 L_sib_loop
    s_branch L_sib_fail
L_sib_done:
    v_xor_b32 v44, v123, v0
    v_and_b32 v44, s7, v44
    v_cmp_ne_u32 vcc, 0, v44
    s_cbranch_vccnz L_sib_fail
    s_mov_b64 exec, 1
    ds_write_b32 v15, v10 offset:864
    s_mov_b64 exec, -1
L_sib_fail:
    s_mov_b64 exec, -1
    v_not_b32 v112, v7
    s_mov_b64 s[66:67], -1
    s_mov_b32 s79, 0
    s_sleep 30
L_st_loop:
    s_mov_b64 exec, s[66:67]
    buffer_load_dwordx4 v[112:115], v21, s[56:59], s74 offen sc1
    s_mov_b64 exec, -1
    s_waitcnt vmcnt(0)
    v_perm_b32 v64, v113, v112, s64
    v_perm_b32 v65, v115, v114, s64
    v_lshl_or_b32 v64, v65, 16, v64
    v_cmp_ne_u32 s[66:67], v64, v7
    s_cmp_eq_u64 s[66:67], 0
    s_cbranch_scc1 L_st_done
    s_add_u32 s79, s79, 1
    s_cmp_lt_u32 s79, 800000
    s_cbranch_scc1 L_st_loop
L_st_done:
    v_and_b32 v44, 0xffffff00, v112
    v_and_b32 v45, 0xffffff00, v113
    s_nop 0
    v_max_f32_dpp v62, v44, v44 row_ror:8 row_mask:0xf bank_mask:0xf
    s_nop 1
    v_max_f32_dpp v62, v62, v62 row_ror:4 row_mask:0xf bank_mask:0xf
    v_mov_b32 v9, v62
    s_nop 1
    v_permlane16_swap_b32 v9, v62
    v_max_f32 v62, v62, v9
    v_mov_b32 v9, v62
    s_nop 1
    v_permlane32_swap_b32 v9, v62
    v_max_f32 v62, v62, v9
    v_sub_f32 v62, v44, v62
    v_exp_f32 v62, v62
    s_waitcnt lgkmcnt(0)
    v_mul_f32 v61, v45, v62
    s_nop 1
    v_add_f32_dpp v61, v61, v61 row_ror:8 row_mask:0xf bank_mask:0xf
    s_nop 1
    v_add_f32_dpp v61, v61, v61 row_ror:4 row_mask:0xf bank_mask:0xf
    v_mov_b32 v9, v61
    s_nop 1
    v_permlane16_swap_b32 v9, v61
    v_add_f32 v61, v61, v9
    v_mov_b32 v9, v61
    s_nop 1
    v_permlane32_swap_b32 v9, v61
    v_add_f32 v61, v61, v9
    v_rcp_f32 v61, v61
    v_mul_f32 v62, v62, v17
    v_mul_f32 v62, v62, v61
    s_movk_i32 s66, 176
    s_mov_b32 s79, 0
L_ow:
    ds_read_b32 v9, v1 offset:1792
    s_waitcnt lgkmcnt(0)
    v_cmp_gt_u32 vcc, s66, v9
    s_cbranch_vccz L_ow_d
    s_sleep 2
    s_add_u32 s79, s79, 1
    s_cmp_lt_u32 s79, 3200000
    s_cbranch_scc1 L_ow
L_ow_d:
    v_not_b32 v116, v7
    s_mov_b64 s[68:69], -1
    s_mov_b32 s79, 0
L_o_loop:
    s_mov_b64 exec, s[68:69]
    buffer_load_dwordx4 v[116:119], v20, s[56:59], s78 offen sc1
    s_mov_b64 exec, -1
    s_sleep 2
    v_perm_b32 v64, v117, v116, s64
    v_perm_b32 v65, v119, v118, s64
    v_lshl_or_b32 v64, v65, 16, v64
    v_cmp_ne_u32 s[68:69], v64, v7
    s_cmp_eq_u64 s[68:69], 0
    s_cbranch_scc1 L_o_done
    s_sleep 2
    v_perm_b32 v64, v117, v116, s64
    v_perm_b32 v65, v119, v118, s64
    v_lshl_or_b32 v64, v65, 16, v64
    v_cmp_ne_u32 s[68:69], v64, v7
    s_cmp_eq_u64 s[68:69], 0
    s_cbranch_scc1 L_o_done
    s_sleep 2
    v_perm_b32 v64, v117, v116, s64
    v_perm_b32 v65, v119, v118, s64
    v_lshl_or_b32 v64, v65, 16, v64
    v_cmp_ne_u32 s[68:69], v64, v7
    s_cmp_eq_u64 s[68:69], 0
    s_cbranch_scc1 L_o_done
    s_waitcnt vmcnt(2)
    v_perm_b32 v64, v117, v116, s64
    v_perm_b32 v65, v119, v118, s64
    v_lshl_or_b32 v64, v65, 16, v64
    v_cmp_ne_u32 s[68:69], v64, v7
    s_cmp_eq_u64 s[68:69], 0
    s_cbranch_scc1 L_o_done
    s_add_u32 s79, s79, 1
    s_cmp_lt_u32 s79, 800000
    s_cbranch_scc1 L_o_loop
L_o_done:
    v_and_b32 v56, 0xffffff00, v116
    v_and_b32 v57, 0xffffff00, v117
    v_and_b32 v58, 0xffffff00, v118
    v_and_b32 v59, 0xffffff00, v119
    v_pk_mul_f32 v[56:57], v[56:57], v[62:63] op_sel:[0,0] op_sel_hi:[1,0]
    v_pk_mul_f32 v[58:59], v[58:59], v[62:63] op_sel:[0,0] op_sel_hi:[1,0]
    s_nop 1
    v_permlane32_swap_b32 v56, v58
    v_permlane32_swap_b32 v57, v59
    v_pk_add_f32 v[56:57], v[56:57], v[58:59]
    s_nop 1
    v_permlane16_swap_b32 v56, v57
    v_add_f32 v56, v56, v57
    s_nop 1
    v_add_f32_dpp v56, v56, v56 row_ror:8 row_mask:0xf bank_mask:0xf
    s_nop 1
    v_add_f32_dpp v56, v56, v56 row_ror:4 row_mask:0xf bank_mask:0xf
    v_cvt_pk_bf16_f32 v56, v56, v56
    s_mov_b32 exec_lo, 0x000f000f
    s_mov_b32 exec_hi, 0x000f000f
    ds_write_b16 v14, v56 offset:768
    s_waitcnt lgkmcnt(0)
    s_barrier
    s_mov_b64 exec, -1
    s_endpgm
L_kv:
    s_sub_u32 s37, s3, 2
    s_cmp_eq_u32 s3, 10
    s_cbranch_scc1 L_w10
    s_waitcnt lgkmcnt(0)
    s_load_dword s34, s[32:33], 0
    s_mov_b64 s[56:57], s[32:33]
    s_mov_b32 s58, 536870912
    s_mov_b32 s59, 0x20000
    v_and_b32 v9, 1, v2
    v_cmp_eq_u32 vcc, 1, v9
    v_mov_b32 v10, 0x0c0c0100
    v_mov_b32 v11, 0x01000c0c
    v_cndmask_b32 v10, v10, v11, vcc
    v_mov_b32 v11, 0x0c0c0302
    v_mov_b32 v12, 0x03020c0c
    v_cndmask_b32 v11, v11, v12, vcc
    v_mov_b32 v12, 0x0c0c0c0c
    v_lshrrev_b32 v9, 1, v6
    v_cmp_eq_u32 vcc, 0, v9
    s_mov_b32 s60, 0x07060500
    s_nop 0
    v_cndmask_b32 v16, v12, v10, vcc
    v_cndmask_b32 v20, v12, v11, vcc
    v_cmp_eq_u32 vcc, 1, v9
    s_mov_b32 s61, 0x07060501
    s_nop 0
    v_cndmask_b32 v17, v12, v10, vcc
    v_cndmask_b32 v21, v12, v11, vcc
    v_cmp_eq_u32 vcc, 2, v9
    s_mov_b32 s62, 0x07060502
    s_nop 0
    v_cndmask_b32 v18, v12, v10, vcc
    v_cndmask_b32 v22, v12, v11, vcc
    v_cmp_eq_u32 vcc, 3, v9
    s_mov_b32 s63, 0x07060503
    s_nop 0
    v_cndmask_b32 v19, v12, v10, vcc
    v_cndmask_b32 v23, v12, v11, vcc
    s_mov_b32 s64, 0x0c0c0400
    v_lshl_add_u32 v9, v4, 3, v6
    v_lshrrev_b32 v10, 2, v9
    v_lshlrev_b32 v10, 14, v10
    v_and_b32 v9, 3, v9
    v_lshl_add_u32 v13, v9, 4, v10
    s_lshl_b32 s74, s4, 6
    s_lshl_b32 s75, s37, 16
    s_add_u32 s74, s74, s75
    s_add_u32 s74, s74, 1114112
    s_lshl_b32 s75, s37, 7
    v_lshl_add_u32 v9, v6, 4, s75
    v_mul_u32_u24 v144, 2304, v5
    v_add_u32 v144, v144, v9
    v_mul_u32_u24 v145, 1152, v5
    v_add_u32 v145, v145, v9
    v_min_u32 v10, 1, v5
    v_mul_u32_u24 v151, 1152, v10
    v_add_u32 v151, v151, v9
    s_and_b32 s75, s4, 1
    s_lshl_b32 s75, s75, 3
    v_lshl_add_u32 v147, v5, 2, s75
    v_lshlrev_b32 v14, 2, v5
    s_mov_b64 s[48:49], s[30:31]
    s_mov_b32 s50, 1152
    s_mov_b32 s51, 0x20000
    s_mov_b64 s[52:53], s[26:27]
    s_mov_b32 s54, 1152
    s_mov_b32 s55, 0x20000
    s_lshr_b32 s75, s2, 2
    s_lshl_b32 s75, s75, 7
    s_and_b32 s76, s2, 1
    s_lshl_b32 s76, s76, 6
    s_add_u32 s75, s75, s76
    s_and_b32 s76, s2, 2
    s_lshl_b32 s76, s76, 2
    s_add_u32 s77, s75, s76
    v_and_b32 v9, 3, v2
    v_lshl_add_u32 v11, v4, 2, v9
    v_lshlrev_b32 v9, 4, v9
    v_bfe_u32 v10, v2, 2, 2
    v_lshl_add_u32 v159, v10, 1, v9
    s_lshl_b32 s76, s2, 14
    s_lshl_b32 s75, s37, 11
    s_add_u32 s76, s76, s75
    s_add_u32 s76, s76, 1114112
    s_lshl_b32 s75, s37, 2
    v_lshl_add_u32 v146, v11, 5, s75
    v_lshlrev_b32 v156, 5, v3
    v_mov_b32 v157, 1
    s_waitcnt lgkmcnt(0)
    s_add_u32 s34, s34, 0x01010101
    s_cmp_eq_u32 s34, 0
    s_cselect_b32 s34, 0x01010101, s34
    v_mov_b32 v7, s34
    s_cmp_ge_u32 s2, 36
    s_cbranch_scc1 L_nored0
    s_cmp_lg_u32 s3, 2
    s_cbranch_scc1 L_nored0
    buffer_load_ushort v149, v159, s[52:55], s77 offen nt
    buffer_load_ushort v12, v159, s[48:51], s77 offen nt
L_nored0:
    s_lshl_b32 s38, s37, 12
    s_add_u32 s38, s38, 45056
    v_and_b32 v9, 3, v3
    v_lshrrev_b32 v10, 2, v3
    v_lshl_add_u32 v9, v9, 2, v10
    v_xor_b32 v10, v4, v3
    v_lshlrev_b32 v10, 4, v10
    v_lshl_add_u32 v9, v9, 8, v10
    v_add_u32 v140, s38, v9
    v_xor_b32 v141, 64, v140
    v_xor_b32 v142, 128, v140
    v_xor_b32 v143, 192, v140
    v_lshrrev_b32 v9, 3, v3
    v_lshlrev_b32 v10, 8, v9
    v_lshl_add_u32 v10, v4, 4, v10
    s_lshl_b32 s66, s37, 4
    v_lshl_add_u32 v150, v5, 8, s66
    s_add_u32 s66, s75, 57
    s_barrier
    s_mov_b32 s79, 0
L_qf:
    ds_read_b32 v9, v15 offset:848
    s_waitcnt lgkmcnt(0)
    v_cmp_gt_u32 vcc, 1, v9
    s_cbranch_vccz L_qf_d
    s_sleep 2
    s_add_u32 s79, s79, 1
    s_cmp_lt_u32 s79, 3200000
    s_cbranch_scc1 L_qf
L_qf_d:
    ds_read_b128 v[116:119], v10 offset:0
    ds_read_b128 v[120:123], v10 offset:64
    ds_read_b128 v[124:127], v10 offset:128
    ds_read_b128 v[128:131], v10 offset:192
    s_mov_b32 s79, 0
L_kw:
    ds_read_b32 v9, v1 offset:1792
    s_waitcnt lgkmcnt(0)
    v_cmp_gt_u32 vcc, s66, v9
    s_cbranch_vccz L_kw_d
    s_sleep 1
    s_add_u32 s79, s79, 1
    s_cmp_lt_u32 s79, 3200000
    s_cbranch_scc1 L_kw
L_kw_d:
    ds_read_b128 v[84:87], v140 offset:0
    ds_read_b128 v[88:91], v141 offset:0
    ds_read_b128 v[92:95], v142 offset:0
    ds_read_b128 v[96:99], v143 offset:0
    ds_read_b128 v[100:103], v140 offset:32768
    ds_read_b128 v[104:107], v141 offset:32768
    ds_read_b128 v[108:111], v142 offset:32768
    ds_read_b128 v[112:115], v143 offset:32768
    s_waitcnt lgkmcnt(7)
    v_mfma_f32_16x16x32_bf16 v[132:135], v[84:87], v[116:119], 0
    s_waitcnt lgkmcnt(6)
    v_mfma_f32_16x16x32_bf16 v[132:135], v[88:91], v[120:123], v[132:135]
    s_waitcnt lgkmcnt(5)
    v_mfma_f32_16x16x32_bf16 v[132:135], v[92:95], v[124:127], v[132:135]
    s_waitcnt lgkmcnt(4)
    v_mfma_f32_16x16x32_bf16 v[132:135], v[96:99], v[128:131], v[132:135]
    s_waitcnt lgkmcnt(3)
    v_mfma_f32_16x16x32_bf16 v[136:139], v[100:103], v[116:119], 0
    s_waitcnt lgkmcnt(2)
    v_mfma_f32_16x16x32_bf16 v[136:139], v[104:107], v[120:123], v[136:139]
    s_waitcnt lgkmcnt(1)
    v_mfma_f32_16x16x32_bf16 v[136:139], v[108:111], v[124:127], v[136:139]
    s_waitcnt lgkmcnt(0)
    v_mfma_f32_16x16x32_bf16 v[136:139], v[112:115], v[128:131], v[136:139]
    s_mov_b32 exec_lo, 0x01010101
    s_mov_b32 exec_hi, 0x01010101
    ds_write_b128 v150, v[132:135] offset:2048
    s_nop 4
    ds_write_b128 v150, v[136:139] offset:2176
    s_mov_b64 exec, 1
    ds_add_u32 v15, v157 offset:856
    s_mov_b64 exec, -1
    s_waitcnt vmcnt(0)
L_tail:
    s_mov_b32 s79, 0
L_hf:
    ds_read_b32 v9, v15 offset:852
    ds_read_b32 v152, v147 offset:640
    ds_read_b32 v153, v147 offset:672
    ds_read_b32 v154, v147 offset:704
    ds_read_b32 v148, v15 offset:832
    s_waitcnt lgkmcnt(0)
    v_cmp_gt_u32 vcc, 1, v9
    s_cbranch_vccz L_hf_d
    s_sleep 4
    s_add_u32 s79, s79, 1
    s_cmp_lt_u32 s79, 3200000
    s_cbranch_scc1 L_hf
L_hf_d:
    v_cmp_gt_u32 vcc, 2, v5
    v_sub_f32 v148, 1.0, v148
    s_nop 0
    v_cndmask_b32 v154, 0, v154, vcc
    v_mul_f32 v152, v152, v148
    v_mul_f32 v153, v153, v148
    v_mul_f32 v154, v154, v148
    v_cvt_pk_bf16_f32 v152, v152, v153
    v_cvt_pk_bf16_f32 v153, v154, v154
    v_perm_b32 v84, v152, v152, v16
    v_perm_b32 v85, v152, v152, v17
    v_perm_b32 v86, v152, v152, v18
    v_perm_b32 v87, v152, v152, v19
    v_perm_b32 v88, v152, v152, v20
    v_perm_b32 v89, v152, v152, v21
    v_perm_b32 v90, v152, v152, v22
    v_perm_b32 v91, v152, v152, v23
    v_perm_b32 v92, v153, v153, v16
    v_perm_b32 v93, v153, v153, v17
    v_perm_b32 v94, v153, v153, v18
    v_perm_b32 v95, v153, v153, v19
    s_movk_i32 s66, 197
    s_movk_i32 s67, 215
    v_not_b32 v32, v7
    s_mov_b64 s[68:69], -1
    v_not_b32 v36, v7
    s_mov_b64 s[70:71], -1
    s_mov_b32 s79, 0
L_w2f:
    ds_read_b32 v9, v1 offset:1792
    s_waitcnt lgkmcnt(0)
    v_cmp_gt_u32 vcc, s66, v9
    s_cbranch_vccz L_w2f_d
    s_sleep 4
    s_add_u32 s79, s79, 1
    s_cmp_lt_u32 s79, 3200000
    s_cbranch_scc1 L_w2f
L_w2f_d:
    ds_read_b128 v[72:75], v145 offset:23552
    ds_read_b128 v[76:79], v145 offset:32768
    ds_read_b128 v[80:83], v151 offset:41984
    s_waitcnt lgkmcnt(0)
    v_mfma_f32_16x16x32_bf16 v[24:27], v[84:87], v[72:75], 0
    v_mfma_f32_16x16x32_bf16 v[24:27], v[88:91], v[76:79], v[24:27]
    v_mfma_f32_16x16x32_bf16 v[24:27], v[92:95], v[80:83], v[24:27]
    s_barrier
    ds_read_b32 v152, v14 offset:768
    ds_read_b128 v[64:67], v144 offset:5120
    ds_read_b128 v[68:71], v144 offset:6272
    s_waitcnt lgkmcnt(2)
    v_perm_b32 v96, v152, v152, v16
    v_perm_b32 v97, v152, v152, v17
    v_perm_b32 v98, v152, v152, v18
    v_perm_b32 v99, v152, v152, v19
    v_perm_b32 v100, v152, v152, v20
    v_perm_b32 v101, v152, v152, v21
    v_perm_b32 v102, v152, v152, v22
    v_perm_b32 v103, v152, v152, v23
    s_waitcnt lgkmcnt(0)
    v_mfma_f32_16x16x32_bf16 v[24:27], v[96:99], v[64:67], v[24:27]
    v_mfma_f32_16x16x32_bf16 v[24:27], v[100:103], v[68:71], v[24:27]
    s_nop 7
    v_permlane32_swap_b32 v24, v28
    v_permlane32_swap_b32 v25, v29
    v_permlane32_swap_b32 v26, v30
    v_permlane32_swap_b32 v27, v31
    v_add_f32_dpp v24, v28, v24 row_ror:8 row_mask:0xf bank_mask:0xf
    v_add_f32_dpp v25, v29, v25 row_ror:8 row_mask:0xf bank_mask:0xf
    v_add_f32_dpp v26, v30, v26 row_ror:8 row_mask:0xf bank_mask:0xf
    v_add_f32_dpp v27, v31, v27 row_ror:8 row_mask:0xf bank_mask:0xf
    v_perm_b32 v24, v24, v7, s60
    v_perm_b32 v25, v25, v7, s61
    v_perm_b32 v26, v26, v7, s62
    v_perm_b32 v27, v27, v7, s63
    s_mov_b64 exec, 0x00ff00ff
    buffer_store_dwordx4 v[24:27], v13, s[56:59], s74 offen sc1
    s_mov_b64 exec, -1
    s_cmp_ge_u32 s2, 36
    s_cbranch_scc1 L_fin
    s_cmp_eq_u32 s3, 10
    s_cbranch_scc1 L_fin
    s_mov_b32 s79, 0
    s_sleep 12
L_f_loop:
    s_mov_b64 exec, s[68:69]
    s_cbranch_execz L_f_s0
    buffer_load_dwordx4 v[32:35], v8, s[56:59], s76 offen offset:0 sc1
L_f_s0:
    s_mov_b64 exec, s[70:71]
    s_cbranch_execz L_f_s1
    buffer_load_dwordx4 v[36:39], v8, s[56:59], s76 offen offset:1024 sc1
L_f_s1:
    s_mov_b64 exec, -1
    s_sleep 1
    v_perm_b32 v88, v33, v32, s64
    v_perm_b32 v89, v35, v34, s64
    v_lshl_or_b32 v88, v89, 16, v88
    v_perm_b32 v90, v37, v36, s64
    v_perm_b32 v91, v39, v38, s64
    v_lshl_or_b32 v90, v91, 16, v90
    v_cmp_ne_u32 s[68:69], v88, v7
    v_cmp_ne_u32 s[70:71], v90, v7
    s_or_b64 vcc, s[68:69], s[70:71]
    s_cbranch_scc0 L_f_done
    s_sleep 1
    v_perm_b32 v88, v33, v32, s64
    v_perm_b32 v89, v35, v34, s64
    v_lshl_or_b32 v88, v89, 16, v88
    v_perm_b32 v90, v37, v36, s64
    v_perm_b32 v91, v39, v38, s64
    v_lshl_or_b32 v90, v91, 16, v90
    v_cmp_ne_u32 s[68:69], v88, v7
    v_cmp_ne_u32 s[70:71], v90, v7
    s_or_b64 vcc, s[68:69], s[70:71]
    s_cbranch_scc0 L_f_done
    s_sleep 1
    v_perm_b32 v88, v33, v32, s64
    v_perm_b32 v89, v35, v34, s64
    v_lshl_or_b32 v88, v89, 16, v88
    v_perm_b32 v90, v37, v36, s64
    v_perm_b32 v91, v39, v38, s64
    v_lshl_or_b32 v90, v91, 16, v90
    v_cmp_ne_u32 s[68:69], v88, v7
    v_cmp_ne_u32 s[70:71], v90, v7
    s_or_b64 vcc, s[68:69], s[70:71]
    s_cbranch_scc0 L_f_done
    s_sleep 1
    v_perm_b32 v88, v33, v32, s64
    v_perm_b32 v89, v35, v34, s64
    v_lshl_or_b32 v88, v89, 16, v88
    v_perm_b32 v90, v37, v36, s64
    v_perm_b32 v91, v39, v38, s64
    v_lshl_or_b32 v90, v91, 16, v90
    v_cmp_ne_u32 s[68:69], v88, v7
    v_cmp_ne_u32 s[70:71], v90, v7
    s_or_b64 vcc, s[68:69], s[70:71]
    s_cbranch_scc0 L_f_done
    s_waitcnt vmcnt(24)
    s_add_u32 s79, s79, 1
    s_cmp_lt_u32 s79, 800000
    s_cbranch_scc1 L_f_loop
L_f_done:
    v_and_b32 v84, 0xffffff00, v32
    v_and_b32 v85, 0xffffff00, v33
    v_and_b32 v86, 0xffffff00, v34
    v_and_b32 v87, 0xffffff00, v35
    v_and_b32 v88, 0xffffff00, v36
    v_and_b32 v89, 0xffffff00, v37
    v_and_b32 v90, 0xffffff00, v38
    v_and_b32 v91, 0xffffff00, v39
    v_pk_add_f32 v[84:85], v[84:85], v[88:89]
    v_pk_add_f32 v[86:87], v[86:87], v[90:91]
    s_nop 1
    v_permlane32_swap_b32 v84, v86
    v_permlane32_swap_b32 v85, v87
    v_pk_add_f32 v[84:85], v[84:85], v[86:87]
    s_nop 1
    v_permlane16_swap_b32 v84, v85
    v_add_f32 v84, v84, v85
    s_nop 1
    v_add_f32_dpp v84, v84, v84 row_ror:8 row_mask:0xf bank_mask:0xf
    s_nop 1
    v_add_f32_dpp v84, v84, v84 row_ror:4 row_mask:0xf bank_mask:0xf
    s_mov_b32 exec_lo, 0x000f000f
    s_mov_b32 exec_hi, 0x000f000f
    ds_write_b32 v146, v84 offset:1152
    s_mov_b64 exec, -1
    v_lshlrev_b32 v149, 16, v149
    s_waitcnt lgkmcnt(0)
    s_barrier
    s_cmp_eq_u32 s3, 2
    s_cbranch_scc0 L_fin
    ds_read_b128 v[84:87], v156 offset:1152
    ds_read_b128 v[88:91], v156 offset:1168
    s_waitcnt lgkmcnt(0)
    v_pk_add_f32 v[84:85], v[84:85], v[88:89]
    v_pk_add_f32 v[86:87], v[86:87], v[90:91]
    v_pk_add_f32 v[84:85], v[84:85], v[86:87]
    v_add_f32 v84, v84, v85
    v_fma_f32 v84, v149, v148, v84
    v_cvt_pk_bf16_f32 v84, v84, v84
    s_mov_b64 exec, 0xffff
    buffer_store_short v84, v159, s[48:51], s77 offen
    s_cmp_eq_u32 s2, 0
    s_cbranch_scc0 L_fin
    s_mov_b64 exec, 1
    s_mov_b32 s66, 0
    buffer_store_dword v7, v15, s[56:59], s66 offen
    s_branch L_fin
L_w10:
    v_lshlrev_b32 v11, 5, v2
    s_waitcnt lgkmcnt(0)
    s_mov_b64 s[40:41], s[8:9]
    s_mov_b32 s42, 1152
    s_mov_b32 s43, 0x20000
    s_mov_b64 s[44:45], s[28:29]
    s_mov_b32 s46, 1152
    s_mov_b32 s47, 0x20000
    s_mov_b64 s[48:49], s[22:23]
    s_mov_b32 s50, 9216
    s_mov_b32 s51, 0x20000
    buffer_load_dwordx4 v[32:35], v11, s[40:43], 0 offen
    buffer_load_dwordx4 v[36:39], v11, s[40:43], 0 offen offset:16
    buffer_load_dwordx4 v[40:43], v11, s[44:47], 0 offen
    buffer_load_dwordx4 v[44:47], v11, s[44:47], 0 offen offset:16
    s_mul_i32 s38, s4, 18
    s_lshr_b32 s38, s38, 2
    s_lshl_b32 s76, s38, 3
    v_lshlrev_b32 v9, 3, v2
    s_mov_b64 exec, 0x1f
    buffer_load_dwordx2 v[56:57], v9, s[48:51], s76 offen nt
    s_lshl_b32 s66, s35, 23
    s_add_u32 s66, s66, 7340032
    s_lshl_b32 s67, s35, 4
    s_add_u32 s67, s67, s36
    s_mul_i32 s67, s67, 18432
    s_mul_i32 s68, s4, 20736
    s_mov_b64 s[40:41], s[12:13]
    s_mov_b32 s42, 134217728
    s_mov_b32 s43, 0x20000
    s_mov_b64 s[44:45], s[16:17]
    s_mov_b32 s46, 4718592
    s_mov_b32 s47, 0x20000
    s_mov_b64 s[48:49], s[24:25]
    s_mov_b32 s50, 5308416
    s_mov_b32 s51, 0x20000
    s_mov_b64 s[52:53], s[20:21]
    s_mov_b32 s54, 5308416
    s_mov_b32 s55, 0x20000
    v_lshlrev_b32 v9, 21, v2
    s_mov_b64 exec, 1
    buffer_load_dword v50, v15, s[40:43], s66 offen nt
    buffer_load_dword v51, v15, s[44:47], s67 offen nt
    buffer_load_dword v52, v15, s[48:51], s68 offen nt
    s_mov_b64 exec, 7
    buffer_load_dword v53, v9, s[52:55], 0 offen
    s_mov_b64 exec, -1
    s_waitcnt lgkmcnt(0)
    s_load_dword s34, s[32:33], 0
    s_mov_b64 s[56:57], s[32:33]
    s_mov_b32 s58, 536870912
    s_mov_b32 s59, 0x20000
    v_and_b32 v9, 1, v2
    v_cmp_eq_u32 vcc, 1, v9
    v_mov_b32 v10, 0x0c0c0100
    v_mov_b32 v11, 0x01000c0c
    v_cndmask_b32 v10, v10, v11, vcc
    v_mov_b32 v11, 0x0c0c0302
    v_mov_b32 v12, 0x03020c0c
    v_cndmask_b32 v11, v11, v12, vcc
    v_mov_b32 v12, 0x0c0c0c0c
    v_lshrrev_b32 v9, 1, v6
    v_cmp_eq_u32 vcc, 0, v9
    s_mov_b32 s60, 0x07060500
    s_nop 0
    v_cndmask_b32 v16, v12, v10, vcc
    v_cndmask_b32 v20, v12, v11, vcc
    v_cmp_eq_u32 vcc, 1, v9
    s_mov_b32 s61, 0x07060501
    s_nop 0
    v_cndmask_b32 v17, v12, v10, vcc
    v_cndmask_b32 v21, v12, v11, vcc
    v_cmp_eq_u32 vcc, 2, v9
    s_mov_b32 s62, 0x07060502
    s_nop 0
    v_cndmask_b32 v18, v12, v10, vcc
    v_cndmask_b32 v22, v12, v11, vcc
    v_cmp_eq_u32 vcc, 3, v9
    s_mov_b32 s63, 0x07060503
    s_nop 0
    v_cndmask_b32 v19, v12, v10, vcc
    v_cndmask_b32 v23, v12, v11, vcc
    s_mov_b32 s64, 0x0c0c0400
    v_lshl_add_u32 v9, v4, 3, v6
    v_lshrrev_b32 v10, 2, v9
    v_lshlrev_b32 v10, 14, v10
    v_and_b32 v9, 3, v9
    v_lshl_add_u32 v13, v9, 4, v10
    s_lshl_b32 s74, s4, 6
    s_lshl_b32 s75, s37, 16
    s_add_u32 s74, s74, s75
    s_add_u32 s74, s74, 1114112
    s_lshl_b32 s75, s37, 7
    v_lshl_add_u32 v9, v6, 4, s75
    v_mul_u32_u24 v144, 2304, v5
    v_add_u32 v144, v144, v9
    v_mul_u32_u24 v145, 1152, v5
    v_add_u32 v145, v145, v9
    v_min_u32 v10, 1, v5
    v_mul_u32_u24 v151, 1152, v10
    v_add_u32 v151, v151, v9
    s_and_b32 s75, s4, 1
    s_lshl_b32 s75, s75, 3
    v_lshl_add_u32 v147, v5, 2, s75
    v_lshlrev_b32 v14, 2, v5
    s_mov_b64 s[48:49], s[30:31]
    s_mov_b32 s50, 1152
    s_mov_b32 s51, 0x20000
    s_mov_b64 s[52:53], s[26:27]
    s_mov_b32 s54, 1152
    s_mov_b32 s55, 0x20000
    s_lshr_b32 s75, s2, 2
    s_lshl_b32 s75, s75, 7
    s_and_b32 s76, s2, 1
    s_lshl_b32 s76, s76, 6
    s_add_u32 s75, s75, s76
    s_and_b32 s76, s2, 2
    s_lshl_b32 s76, s76, 2
    s_add_u32 s77, s75, s76
    v_and_b32 v9, 3, v2
    v_lshl_add_u32 v11, v4, 2, v9
    v_lshlrev_b32 v9, 4, v9
    v_bfe_u32 v10, v2, 2, 2
    v_lshl_add_u32 v159, v10, 1, v9
    s_lshl_b32 s76, s2, 14
    s_lshl_b32 s75, s37, 11
    s_add_u32 s76, s76, s75
    s_add_u32 s76, s76, 1114112
    s_lshl_b32 s75, s37, 2
    v_lshl_add_u32 v146, v11, 5, s75
    v_lshlrev_b32 v156, 5, v3
    v_mov_b32 v157, 1
    s_waitcnt lgkmcnt(0)
    s_add_u32 s34, s34, 0x01010101
    s_cmp_eq_u32 s34, 0
    s_cselect_b32 s34, 0x01010101, s34
    v_mov_b32 v7, s34
    s_barrier
    v_mov_b32 v148, 0
    s_waitcnt vmcnt(5)
    v_dot2_f32_bf16 v148, v32, v40, v148
    v_dot2_f32_bf16 v148, v33, v41, v148
    v_dot2_f32_bf16 v148, v34, v42, v148
    v_dot2_f32_bf16 v148, v35, v43, v148
    v_dot2_f32_bf16 v148, v36, v44, v148
    v_dot2_f32_bf16 v148, v37, v45, v148
    v_dot2_f32_bf16 v148, v38, v46, v148
    v_dot2_f32_bf16 v148, v39, v47, v148
    s_nop 2
    v_add_f32_dpp v148, v148, v148 row_ror:8 row_mask:0xf bank_mask:0xf
    s_nop 1
    v_add_f32_dpp v148, v148, v148 row_ror:4 row_mask:0xf bank_mask:0xf
    s_nop 1
    v_add_f32_dpp v148, v148, v148 row_ror:2 row_mask:0xf bank_mask:0xf
    s_nop 1
    v_add_f32_dpp v148, v148, v148 row_ror:1 row_mask:0xf bank_mask:0xf
    s_nop 1
    v_mov_b32 v9, v148
    s_nop 1
    v_permlane16_swap_b32 v9, v148
    v_add_f32 v148, v148, v9
    v_mov_b32 v9, v148
    s_nop 1
    v_permlane32_swap_b32 v9, v148
    v_add_f32 v148, v148, v9
    v_mul_f32 v148, 0xbfb8aa3b, v148
    v_exp_f32 v148, v148
    s_nop 0
    v_add_f32 v148, 1.0, v148
    v_rcp_f32 v148, v148
    s_mov_b64 exec, 1
    ds_write_b32 v15, v148 offset:832
    ds_add_u32 v15, v157 offset:856
    s_mov_b64 exec, -1
    v_add_u32 v9, s38, v2
    v_lshrrev_b32 v10, 4, v9
    v_lshlrev_b32 v10, 8, v10
    v_and_b32 v11, 1, v9
    v_lshl_add_u32 v10, v11, 7, v10
    v_bfe_u32 v11, v9, 1, 3
    v_lshl_add_u32 v58, v11, 4, v10
    s_mov_b32 s66, 131072
    s_mov_b32 s67, 149504
    s_mov_b32 s68, 167936
    s_movk_i32 s69, 112
    s_mov_b32 s79, 0
L_hp:
    ds_read_b32 v9, v1 offset:1792
    s_waitcnt lgkmcnt(0)
    v_cmp_gt_u32 vcc, s69, v9
    s_cbranch_vccz L_hp_d
    s_sleep 4
    s_add_u32 s79, s79, 1
    s_cmp_lt_u32 s79, 3200000
    s_cbranch_scc1 L_hp
L_hp_d:
    s_waitcnt vmcnt(0)
    s_mov_b64 exec, 0x1f
    v_lshlrev_b32 v76, 16, v56
    v_and_b32 v77, 0xffff0000, v56
    v_lshlrev_b32 v78, 16, v57
    v_and_b32 v79, 0xffff0000, v57
    v_not_b32 v116, v7
    s_mov_b64 s[40:41], 0x1f
    v_not_b32 v120, v7
    s_mov_b64 s[42:43], 0x1f
    v_not_b32 v124, v7
    s_mov_b64 s[44:45], 0x1f
    s_mov_b32 s79, 0
    s_sleep 50
L_h_loop:
    s_mov_b64 exec, s[40:41]
    s_cbranch_execz L_h_s0
    buffer_load_dwordx4 v[116:119], v58, s[56:59], s66 offen sc1
L_h_s0:
    s_mov_b64 exec, s[42:43]
    s_cbranch_execz L_h_s1
    buffer_load_dwordx4 v[120:123], v58, s[56:59], s67 offen sc1
L_h_s1:
    s_mov_b64 exec, s[44:45]
    s_cbranch_execz L_h_s2
    buffer_load_dwordx4 v[124:127], v58, s[56:59], s68 offen sc1
L_h_s2:
    s_mov_b64 exec, 0x1f
    s_waitcnt vmcnt(0)
    v_perm_b32 v40, v117, v116, s64
    v_perm_b32 v41, v119, v118, s64
    v_lshl_or_b32 v40, v41, 16, v40
    v_perm_b32 v42, v121, v120, s64
    v_perm_b32 v43, v123, v122, s64
    v_lshl_or_b32 v42, v43, 16, v42
    v_perm_b32 v44, v125, v124, s64
    v_perm_b32 v45, v127, v126, s64
    v_lshl_or_b32 v44, v45, 16, v44
    v_cmp_ne_u32 s[40:41], v40, v7
    v_cmp_ne_u32 s[42:43], v42, v7
    v_cmp_ne_u32 s[44:45], v44, v7
    s_or_b64 vcc, s[40:41], s[42:43]
    s_or_b64 vcc, vcc, s[44:45]
    s_cbranch_scc0 L_h_done
    s_add_u32 s79, s79, 1
    s_cmp_lt_u32 s79, 12
    s_cbranch_scc1 L_h_loop
    s_waitcnt vmcnt(0)
    v_perm_b32 v40, v117, v116, s64
    v_perm_b32 v41, v119, v118, s64
    v_lshl_or_b32 v40, v41, 16, v40
    v_perm_b32 v42, v121, v120, s64
    v_perm_b32 v43, v123, v122, s64
    v_lshl_or_b32 v42, v43, 16, v42
    v_perm_b32 v44, v125, v124, s64
    v_perm_b32 v45, v127, v126, s64
    v_lshl_or_b32 v44, v45, 16, v44
    v_cmp_ne_u32 s[40:41], v40, v7
    v_cmp_ne_u32 s[42:43], v42, v7
    v_cmp_ne_u32 s[44:45], v44, v7
    s_or_b64 vcc, s[40:41], s[42:43]
    s_or_b64 vcc, vcc, s[44:45]
    s_cbranch_scc0 L_h_done
    s_xor_b32 s66, s66, 262144
    s_xor_b32 s67, s67, 262144
    s_xor_b32 s68, s68, 262144
    s_cmp_lt_u32 s79, 800000
    s_cbranch_scc1 L_h_loop
L_h_done:
    v_and_b32 v64, 0xffffff00, v116
    v_and_b32 v65, 0xffffff00, v117
    v_and_b32 v66, 0xffffff00, v118
    v_and_b32 v67, 0xffffff00, v119
    v_and_b32 v68, 0xffffff00, v120
    v_and_b32 v69, 0xffffff00, v121
    v_and_b32 v70, 0xffffff00, v122
    v_and_b32 v71, 0xffffff00, v123
    v_and_b32 v72, 0xffffff00, v124
    v_and_b32 v73, 0xffffff00, v125
    v_and_b32 v74, 0xffffff00, v126
    v_and_b32 v75, 0xffffff00, v127
    v_pk_add_f32 v[64:65], v[64:65], v[68:69]
    v_pk_add_f32 v[66:67], v[66:67], v[70:71]
    v_pk_add_f32 v[72:73], v[72:73], v[76:77]
    v_pk_add_f32 v[74:75], v[74:75], v[78:79]
    v_pk_add_f32 v[64:65], v[64:65], v[72:73]
    v_pk_add_f32 v[66:67], v[66:67], v[74:75]
    v_mov_b32 v76, 0xc0135761
    v_mov_b32 v77, 0xbdd2d3e8
    v_mul_f32 v68, v64, v64
    v_mul_f32 v69, v65, v65
    v_mul_f32 v70, v66, v66
    v_mul_f32 v71, v67, v67
    v_fma_f32 v68, v68, v77, v76
    v_fma_f32 v69, v69, v77, v76
    v_fma_f32 v70, v70, v77, v76
    v_fma_f32 v71, v71, v77, v76
    v_mul_f32 v68, v68, v64
    v_mul_f32 v69, v69, v65
    v_mul_f32 v70, v70, v66
    v_mul_f32 v71, v71, v67
    v_exp_f32 v68, v68
    v_exp_f32 v69, v69
    v_exp_f32 v70, v70
    v_exp_f32 v71, v71
    v_add_f32 v68, 1.0, v68
    v_add_f32 v69, 1.0, v69
    v_add_f32 v70, 1.0, v70
    v_add_f32 v71, 1.0, v71
    v_rcp_f32 v68, v68
    v_rcp_f32 v69, v69
    v_rcp_f32 v70, v70
    v_rcp_f32 v71, v71
    v_mul_f32 v64, v64, v68
    v_mul_f32 v65, v65, v69
    v_mul_f32 v66, v66, v70
    v_mul_f32 v67, v67, v71
    ds_write_b128 v8, v[64:67] offset:640
    s_mov_b64 exec, 1
    ds_write_b32 v15, v157 offset:852
    s_mov_b64 exec, -1
    s_branch L_tail
L_fin:
L_end:
    s_endpgm
L_codeend:

.section .rodata,"a"
.p2align 6
.amdhsa_kernel gated_mix__sliding_block_cached__dense_activation_gelu__decode_kernel
  .amdhsa_next_free_vgpr 168
  .amdhsa_next_free_sgpr 100
  .amdhsa_accum_offset 168
  .amdhsa_group_segment_fixed_size 0
  .amdhsa_kernarg_size 112
  .amdhsa_user_sgpr_count 2
  .amdhsa_user_sgpr_kernarg_segment_ptr 1
  .amdhsa_system_sgpr_workgroup_id_x 1
.end_amdhsa_kernel
```
